```python
import torch

def _softmax(x, axis=-1):
    return torch.softmax(x, dim=axis)
def _gelu(x):
    return torch.nn.functional.gelu(x, approximate="tanh")
def _silu(x):
    return torch.nn.functional.silu(x)
def _sigmoid(x):
    return torch.sigmoid(x)
def _layernorm(x, axis=-1, eps=1e-5):
    m = x.mean(dim=axis, keepdim=True)
    v = x.var(dim=axis, keepdim=True, unbiased=False)
    return (x - m) / torch.sqrt(v + eps)
def _scatter_add(tgt, idx, src, axis=0):
    return tgt.clone().index_add_(axis, idx, src)
def _segment_sum(src, seg, n):
    out = torch.zeros((n,) + src.shape[1:], dtype=src.dtype)
    return out.index_add_(0, seg, src)
def _pad(x, pw):
    flat = tuple(v for pair in reversed(pw) for v in pair)
    return torch.nn.functional.pad(x, flat)

kernel_name = 'standalone__batchnorm__sampling'

def setup_inputs():

    _w = (lambda a: (lambda t: t.to(torch.bfloat16) if t.is_floating_point() else t)(torch.as_tensor(a)))
    B, S, C = 1024, 16, 576
    K = 3
    return {
        "x": _w((lambda *s: torch.randn(*s, dtype=torch.bfloat16) * 0.05)(B, S, C)),
        "w": _w((lambda *s: torch.randn(*s, dtype=torch.bfloat16) * 0.05)(K, C, C) * (1.0 / (K * C) ** 0.5)),
        "mean": _w((lambda *s: torch.randn(*s, dtype=torch.bfloat16) * 0.05)(C) * 0.1),
        "var": _w(torch.abs((lambda *s: torch.randn(*s, dtype=torch.bfloat16) * 0.05)(C)) + 0.5),
        "g": _w((lambda *s: torch.randn(*s, dtype=torch.bfloat16) * 0.05)(C) + 1.0),
        "b": _w((lambda *s: torch.randn(*s, dtype=torch.bfloat16) * 0.05)(C) * 0.1),
    }

def reference(x, w, mean, var, g, b):
    K = 3
    P = K // 2
    S = x.shape[1]
    xp = _pad(x, ((0, 0), (P, P), (0, 0)))
    y = sum(torch.einsum('bsc,cd->bsd', xp[:, k:k + S, :], w[k]) for k in range(K))
    inv_std = 1.0 / torch.sqrt(var + 1e-5)
    y = (y - mean) * (g * inv_std) + b
    return _silu(y)
```

```asm
; @launch grid=(256,1,1) block=(256,1,1) lds=158784
.amdgcn_target "amdgcn-amd-amdhsa--gfx950"
.text
.globl standalone__batchnorm__sampling_kernel
.p2align 12
.p2align 8
.type standalone__batchnorm__sampling_kernel,@function
standalone__batchnorm__sampling_kernel:
    s_cmp_ge_u32 s2, 256
    s_cbranch_scc1 L_end0
    s_load_dwordx16 s[4:19], s[0:1], 0
    v_lshrrev_b32 v92, 6, v0
    v_lshlrev_b32 v28, 2, v0
    v_readfirstlane_b32 s36, v92
    v_and_b32 v0, 63, v0
    s_and_b32 s46, s2, 7
    s_lshr_b32 s39, s2, 3
    s_and_b32 s38, s39, 3
    s_lshr_b32 s47, s39, 2
    s_lshl_b32 s46, s46, 3
    s_add_u32 s37, s46, s47
    s_getpc_b64 s[58:59]
L_pc:
    s_lshl_b32 s46, s39, 2
    s_add_u32 s46, s46, s36
    s_mul_i32 s46, s46, 256
    v_and_b32 v92, 1, v0
    v_lshlrev_b32 v92, 7, v92
    v_add_u32 v92, s46, v92
    v_min_u32 v92, L_code_end-L_pc-4, v92
    global_load_dword v23, v92, s[58:59]
    v_lshrrev_b32 v92, 3, v0
    v_mul_u32_u24 v92, 18432, v92
    v_and_b32 v93, 7, v0
    v_lshrrev_b32 v94, 4, v0
    v_xor_b32 v93, v93, v94
    v_lshl_add_u32 v92, v93, 4, v92
    s_mul_i32 s46, s36, 4608
    v_add_u32 v8, s46, v92
    v_xor_b32 v92, 64, v8
    v_add_u32 v12, 147456, v92
    v_add_u32 v9, 128, v8
    v_add_u32 v13, 128, v12
    v_add_u32 v10, 256, v8
    v_add_u32 v14, 256, v12
    v_add_u32 v11, 384, v8
    v_add_u32 v15, 384, v12
    s_mul_i32 s46, s36, 448
    v_add_u32 v92, s46, v0
    v_lshlrev_b32 v93, 4, v92
    v_mul_u32_u24 v92, 3641, v92
    s_mul_i32 s46, s37, 294912
    s_lshl_b32 s47, s38, 8
    s_mul_i32 s52, s38, 224
    s_sub_u32 s52, 768, s52
    s_movk_i32 s42, -288
    s_mov_b32 s22, 294912
    s_mov_b32 s23, 0x20000
    s_mov_b32 s27, 0x20000
    s_sub_u32 s26, 1990656, s47
    s_lshl_b32 s57, s36, 12
    s_mul_i32 s3, s36, 7168
    s_movk_i32 s48, 864
    s_movk_i32 s49, 4608
    s_mov_b32 s44, 626688
    s_mov_b32 m0, s57
    s_lshr_b32 s53, s36, 1
    s_and_b32 s54, s36, 1
    s_cbranch_scc1 L_tx
    v_min_u32 v94, 53, v0
    v_mul_u32_u24 v95, 3641, v94
    v_lshrrev_b32 v95, 16, v95
    v_mul_u32_u24 v95, 661248, v95
    v_lshl_add_u32 v22, v94, 7, v95
    s_mul_i32 s55, s39, 2304
    v_add_u32 v22, s55, v22
    s_mov_b32 s56, 73728
    s_branch L_tdone
L_tx:
    s_lshl_b32 s55, s38, 6
    v_add_u32 v94, s55, v0
    v_mul_u32_u24 v22, 1152, v94
    s_movk_i32 s56, 128
L_tdone:
    s_mul_i32 s55, s56, s53
    s_mov_b32 s35, 0x20000
    s_waitcnt lgkmcnt(0)
    s_add_u32 s20, s4, s46
    s_addc_u32 s21, s5, 0
    s_cmp_eq_u32 s54, 1
    s_cselect_b32 s32, s20, s6
    s_cselect_b32 s33, s21, s7
    s_cselect_b32 s34, s22, s26
    s_lshr_b32 s41, 3, s36
    s_and_b32 s41, s41, 1
    s_cbranch_scc0 L_nopt
    buffer_load_dword v23, v22, s[32:35], s55 offen
L_nopt:
    s_add_u32 s24, s6, s47
    s_addc_u32 s25, s7, 0
    buffer_load_dwordx4 v8, s[20:23], 0 offen offset:0 lds
    buffer_load_dwordx4 v9, s[20:23], 0 offen offset:1024 lds
    buffer_load_dwordx4 v10, s[20:23], 0 offen offset:2048 lds
    buffer_load_dwordx4 v11, s[20:23], 0 offen offset:3072 lds
    v_lshrrev_b32 v94, 16, v92
    v_bfe_u32 v95, v92, 18, 1
    v_bfe_u32 v96, v92, 19, 1
    v_lshrrev_b32 v97, 21, v92
    v_mad_i32_i24 v98, v94, s42, v93
    v_sub_u32 v95, v95, v96
    v_mad_u32_u24 v94, v94, s48, v93
    v_bfe_u32 v98, v98, 8, 1
    v_mad_i32_i24 v94, v95, s49, v94
    v_mad_u32_u24 v94, v98, s52, v94
    v_mad_u32_u24 v1, v97, s44, v94
    s_add_u32 m0, s57, 16384
    s_nop 0
    buffer_load_dwordx4 v12, s[20:23], 0 offen offset:0 lds
    v_add_u32 v92, 233024, v92
    v_lshrrev_b32 v94, 16, v92
    v_bfe_u32 v95, v92, 18, 1
    v_bfe_u32 v96, v92, 19, 1
    v_lshrrev_b32 v97, 21, v92
    v_mad_i32_i24 v98, v94, s42, v93
    v_sub_u32 v95, v95, v96
    v_mad_u32_u24 v94, v94, s48, v93
    v_bfe_u32 v98, v98, 8, 1
    v_mad_i32_i24 v94, v95, s49, v94
    v_mad_u32_u24 v94, v98, s52, v94
    v_mad_u32_u24 v2, v97, s44, v94
    buffer_load_dwordx4 v13, s[20:23], 0 offen offset:1024 lds
    v_add_u32 v92, 233024, v92
    v_lshrrev_b32 v94, 16, v92
    v_bfe_u32 v95, v92, 18, 1
    v_bfe_u32 v96, v92, 19, 1
    v_lshrrev_b32 v97, 21, v92
    v_mad_i32_i24 v98, v94, s42, v93
    v_sub_u32 v95, v95, v96
    v_mad_u32_u24 v94, v94, s48, v93
    v_bfe_u32 v98, v98, 8, 1
    v_mad_i32_i24 v94, v95, s49, v94
    v_mad_u32_u24 v94, v98, s52, v94
    v_mad_u32_u24 v3, v97, s44, v94
    buffer_load_dwordx4 v14, s[20:23], 0 offen offset:2048 lds
    v_add_u32 v92, 233024, v92
    v_lshrrev_b32 v94, 16, v92
    v_bfe_u32 v95, v92, 18, 1
    v_bfe_u32 v96, v92, 19, 1
    v_lshrrev_b32 v97, 21, v92
    v_mad_i32_i24 v98, v94, s42, v93
    v_sub_u32 v95, v95, v96
    v_mad_u32_u24 v94, v94, s48, v93
    v_bfe_u32 v98, v98, 8, 1
    v_mad_i32_i24 v94, v95, s49, v94
    v_mad_u32_u24 v94, v98, s52, v94
    v_mad_u32_u24 v4, v97, s44, v94
    buffer_load_dwordx4 v15, s[20:23], 0 offen offset:3072 lds
    v_add_u32 v92, 233024, v92
    v_lshrrev_b32 v94, 16, v92
    v_bfe_u32 v95, v92, 18, 1
    v_bfe_u32 v96, v92, 19, 1
    v_lshrrev_b32 v97, 21, v92
    v_add_u32 v93, 4096, v93
    v_mad_i32_i24 v98, v94, s42, v93
    v_sub_u32 v95, v95, v96
    v_mad_u32_u24 v94, v94, s48, v93
    v_bfe_u32 v98, v98, 8, 1
    v_mad_i32_i24 v94, v95, s49, v94
    v_mad_u32_u24 v94, v98, s52, v94
    v_mad_u32_u24 v5, v97, s44, v94
    s_add_u32 m0, s3, 65536
    s_nop 0
    buffer_load_dwordx4 v1, s[24:27], 0 offen offset:0 lds
    v_add_u32 v92, 233024, v92
    v_lshrrev_b32 v94, 16, v92
    v_bfe_u32 v95, v92, 18, 1
    v_bfe_u32 v96, v92, 19, 1
    v_lshrrev_b32 v97, 21, v92
    v_mad_i32_i24 v98, v94, s42, v93
    v_sub_u32 v95, v95, v96
    v_mad_u32_u24 v94, v94, s48, v93
    v_bfe_u32 v98, v98, 8, 1
    v_mad_i32_i24 v94, v95, s49, v94
    v_mad_u32_u24 v94, v98, s52, v94
    v_mad_u32_u24 v6, v97, s44, v94
    buffer_load_dwordx4 v2, s[24:27], 0 offen offset:1024 lds
    v_add_u32 v92, 233024, v92
    v_lshrrev_b32 v94, 16, v92
    v_bfe_u32 v95, v92, 18, 1
    v_bfe_u32 v96, v92, 19, 1
    v_lshrrev_b32 v97, 21, v92
    v_mad_i32_i24 v98, v94, s42, v93
    v_sub_u32 v95, v95, v96
    v_mad_u32_u24 v94, v94, s48, v93
    v_bfe_u32 v98, v98, 8, 1
    v_mad_i32_i24 v94, v95, s49, v94
    v_mad_u32_u24 v94, v98, s52, v94
    v_mad_u32_u24 v7, v97, s44, v94
    buffer_load_dwordx4 v3, s[24:27], 0 offen offset:2048 lds
    s_add_u32 s28, s16, s46
    s_addc_u32 s29, s17, 0
    s_mov_b32 s30, 294912
    s_mov_b32 s31, 0x20000
    s_mov_b32 s40, 36864
    v_lshrrev_b32 v92, 5, v0
    v_lshlrev_b32 v92, 4, v92
    v_bfe_u32 v93, v0, 2, 3
    v_add_u32 v92, v92, v93
    v_mul_u32_u24 v92, 288, v92
    v_and_b32 v93, 3, v0
    v_lshl_add_u32 v92, v93, 3, v92
    v_add_u32 v20, 256, v92
    s_lshl_b32 s47, s54, 7
    buffer_load_dwordx4 v4, s[24:27], 0 offen offset:3072 lds
    v_add_u32 v16, s47, v92
    v_add_u32 v17, 65536, v16
    v_add_u32 v21, 65536, v20
    v_bfe_u32 v92, v0, 3, 1
    v_lshlrev_b32 v92, 14, v92
    v_and_b32 v93, 7, v0
    v_lshl_add_u32 v92, v93, 7, v92
    v_bfe_u32 v93, v0, 1, 3
    v_lshrrev_b32 v94, 4, v0
    v_xor_b32 v93, v93, v94
    v_lshl_add_u32 v18, v93, 4, v92
    v_xor_b32 v19, 64, v18
    s_lshl_b32 s49, s39, 9
    v_and_b32 v92, 3, v0
    s_add_u32 m0, s3, 69632
    s_nop 0
    buffer_load_dwordx4 v5, s[24:27], 0 offen offset:0 lds
    v_lshlrev_b32 v92, 7, v92
    v_add_u32 v92, s49, v92
    v_add_u32 v92, L_tail-L_pc, v92
    v_min_u32 v52, L_code_end-L_pc-4, v92
    s_lshl_b32 s49, s38, 8
    v_lshrrev_b32 v92, 1, v28
    v_lshrrev_b32 v93, 9, v28
    v_mad_u32_u24 v92, v93, s52, v92
    v_add_u32 v92, s49, v92
    v_min_u32 v27, 1150, v92
    v_mov_b32 v47, 0
    v_mov_b32 v48, 0
    v_mov_b32 v49, 0
    buffer_load_dwordx4 v6, s[24:27], 0 offen offset:1024 lds
    s_cmp_eq_u32 s36, 3
    s_cbranch_scc1 L_skw0
    buffer_load_dwordx4 v7, s[24:27], 0 offen offset:2048 lds
L_skw0:
    s_add_u32 m0, s3, 93184
    s_nop 0
    buffer_load_dwordx4 v1, s[24:27], s40 offen offset:0 lds
    s_mov_b64 vcc, -1
    s_cmp_eq_u32 s36, 1
    s_cbranch_scc1 L_w1
    s_cmp_eq_u32 s36, 2
    s_cbranch_scc1 L_w2
    s_cmp_eq_u32 s36, 3
    s_cbranch_scc1 L_w3
    s_branch L_w0
L_backA:
    buffer_load_dwordx4 v2, s[24:27], s40 offen offset:1024 lds
    v_mov_b32 v208, 0
    v_mov_b32 v209, 0
    v_mov_b32 v210, 0
    v_mov_b32 v211, 0
    v_mov_b32 v212, 0
    v_mov_b32 v213, 0
    v_mov_b32 v214, 0
    v_mov_b32 v215, 0
    v_mov_b32 v216, 0
    v_mov_b32 v217, 0
    v_mov_b32 v218, 0
    v_mov_b32 v219, 0
    v_mov_b32 v220, 0
    v_mov_b32 v221, 0
    buffer_load_dwordx4 v3, s[24:27], s40 offen offset:2048 lds
    v_mov_b32 v222, 0
    v_mov_b32 v223, 0
    v_mov_b32 v224, 0
    v_mov_b32 v225, 0
    v_mov_b32 v226, 0
    v_mov_b32 v227, 0
    v_mov_b32 v228, 0
    v_mov_b32 v229, 0
    v_mov_b32 v230, 0
    v_mov_b32 v231, 0
    v_mov_b32 v232, 0
    v_mov_b32 v233, 0
    v_mov_b32 v234, 0
    v_mov_b32 v235, 0
    buffer_load_dwordx4 v4, s[24:27], s40 offen offset:3072 lds
    v_mov_b32 v236, 0
    v_mov_b32 v237, 0
    v_mov_b32 v238, 0
    v_mov_b32 v239, 0
    v_mov_b32 v240, 0
    v_mov_b32 v241, 0
    v_mov_b32 v242, 0
    v_mov_b32 v243, 0
    v_mov_b32 v244, 0
    v_mov_b32 v245, 0
    v_mov_b32 v246, 0
    v_mov_b32 v247, 0
    v_mov_b32 v248, 0
    v_mov_b32 v249, 0
    s_add_u32 m0, s3, 97280
    s_nop 0
    buffer_load_dwordx4 v5, s[24:27], s40 offen offset:0 lds
    v_mov_b32 v250, 0
    v_mov_b32 v251, 0
    v_mov_b32 v252, 0
    v_mov_b32 v253, 0
    v_mov_b32 v254, 0
    v_mov_b32 v255, 0
    v_accvgpr_write_b32 a0, 0
    v_accvgpr_write_b32 a1, 0
    v_accvgpr_write_b32 a2, 0
    v_accvgpr_write_b32 a3, 0
    v_accvgpr_write_b32 a36, 0
    v_accvgpr_write_b32 a37, 0
    v_accvgpr_write_b32 a38, 0
    v_accvgpr_write_b32 a39, 0
    buffer_load_dwordx4 v6, s[24:27], s40 offen offset:1024 lds
    s_cmp_eq_u32 s36, 3
    s_cbranch_scc1 L_skw1
    buffer_load_dwordx4 v7, s[24:27], s40 offen offset:2048 lds
L_skw1:
    s_cmp_eq_u32 s36, 1
    s_cbranch_scc1 L_tp1
    s_cmp_eq_u32 s36, 2
    s_cbranch_scc1 L_tp2
    s_branch L_tp0
L_back:
    s_mov_b64 vcc, 0
    global_load_ushort v24, v27, s[8:9]
    global_load_ushort v25, v27, s[10:11]
    global_load_ushort v26, v27, s[12:13]
    global_load_ushort v27, v27, s[14:15]
    s_mov_b32 s55, s56
    s_movk_i32 s41, 128
    s_mov_b32 s43, 32768
    s_mov_b32 s40, 73728
    s_mov_b32 s45, 120832
    s_mov_b32 s42, 65536
    s_mov_b32 s44, 0
    s_cmp_eq_u32 s36, 1
    s_cbranch_scc1 L_w1
    s_cmp_eq_u32 s36, 2
    s_cbranch_scc1 L_w2
    s_cmp_eq_u32 s36, 3
    s_cbranch_scc1 L_w3
    s_branch L_w0
L_end0:
    s_endpgm
.p2align 12
L_w0:
    s_cbranch_vccnz L_backA
    s_waitcnt vmcnt(11)
    s_barrier
    ds_read_b64_tr_b16 a[164:165], v17 offset:9216
    ds_read_b64_tr_b16 a[166:167], v17 offset:11520
    ds_read_b128 a[4:7], v18 offset:0
    ds_read_b64_tr_b16 a[168:169], v17 offset:18432
    ds_read_b64_tr_b16 a[170:171], v17 offset:20736
    ds_read_b128 a[8:11], v18 offset:1024
    ds_read_b128 a[12:15], v18 offset:2048
    ds_read_b64_tr_b16 a[160:161], v17 offset:0
    ds_read_b64_tr_b16 a[162:163], v17 offset:2304
    ds_read_b128 a[16:19], v18 offset:3072
    ds_read_b128 a[20:23], v18 offset:4096
    ds_read_b128 a[24:27], v18 offset:5120
    ds_read_b128 a[28:31], v18 offset:6144
    ds_read_b128 a[32:35], v18 offset:7168
    ds_read_b128 a[36:39], v18 offset:8192
    s_waitcnt lgkmcnt(12)
    v_mfma_f32_16x16x32_bf16 v[112:115], a[164:167], a[4:7], 0
    s_add_u32 m0, s43, 0
    s_waitcnt lgkmcnt(9)
    v_mfma_f32_16x16x32_bf16 v[112:115], a[168:171], a[8:11], v[112:115]
    buffer_load_dwordx4 v8, s[20:23], s41 offen offset:0 lds
    s_waitcnt lgkmcnt(8)
    v_mfma_f32_16x16x32_bf16 v[116:119], a[168:171], a[12:15], 0
    v_mfma_f32_16x16x32_bf16 v[116:119], a[164:167], a[8:11], v[116:119]
    ds_read_b64_tr_b16 a[172:173], v17 offset:32
    s_waitcnt lgkmcnt(7)
    v_mfma_f32_16x16x32_bf16 v[116:119], a[160:163], a[4:7], v[116:119]
    buffer_load_dwordx4 v9, s[20:23], s41 offen offset:1024 lds
    ds_read_b64_tr_b16 a[174:175], v17 offset:2336
    v_mfma_f32_16x16x32_bf16 v[120:123], a[160:163], a[8:11], 0
    v_mfma_f32_16x16x32_bf16 v[120:123], a[164:167], a[12:15], v[120:123]
    ds_read_b64_tr_b16 a[176:177], v17 offset:9248
    s_waitcnt lgkmcnt(7)
    v_mfma_f32_16x16x32_bf16 v[120:123], a[168:171], a[16:19], v[120:123]
    v_mfma_f32_16x16x32_bf16 v[124:127], a[168:171], a[20:23], 0
    buffer_load_dwordx4 v10, s[20:23], s41 offen offset:2048 lds
    ds_read_b64_tr_b16 a[178:179], v17 offset:11552
    v_mfma_f32_16x16x32_bf16 v[124:127], a[164:167], a[16:19], v[124:127]
    ds_read_b64_tr_b16 a[180:181], v17 offset:18464
    v_mfma_f32_16x16x32_bf16 v[124:127], a[160:163], a[12:15], v[124:127]
    ds_read_b64_tr_b16 a[182:183], v17 offset:20768
    v_mfma_f32_16x16x32_bf16 v[128:131], a[160:163], a[16:19], 0
    v_mfma_f32_16x16x32_bf16 v[128:131], a[164:167], a[20:23], v[128:131]
    buffer_load_dwordx4 v11, s[20:23], s41 offen offset:3072 lds
    ds_read_b128 a[44:47], v19 offset:0
    s_waitcnt lgkmcnt(7)
    v_mfma_f32_16x16x32_bf16 v[128:131], a[168:171], a[24:27], v[128:131]
    v_mfma_f32_16x16x32_bf16 v[132:135], a[168:171], a[28:31], 0
    ds_read_b128 a[48:51], v19 offset:1024
    v_mfma_f32_16x16x32_bf16 v[132:135], a[164:167], a[24:27], v[132:135]
    s_add_u32 m0, s43, 16384
    ds_read_b128 a[52:55], v19 offset:2048
    v_mfma_f32_16x16x32_bf16 v[132:135], a[160:163], a[20:23], v[132:135]
    buffer_load_dwordx4 v12, s[20:23], s41 offen offset:0 lds
    v_mfma_f32_16x16x32_bf16 v[136:139], a[160:163], a[24:27], 0
    v_mfma_f32_16x16x32_bf16 v[136:139], a[164:167], a[28:31], v[136:139]
    v_mfma_f32_16x16x32_bf16 v[136:139], a[168:171], a[32:35], v[136:139]
    v_mfma_f32_16x16x32_bf16 v[140:143], a[168:171], a[36:39], 0
    buffer_load_dwordx4 v13, s[20:23], s41 offen offset:1024 lds
    v_mfma_f32_16x16x32_bf16 v[140:143], a[164:167], a[32:35], v[140:143]
    v_mfma_f32_16x16x32_bf16 v[140:143], a[160:163], a[28:31], v[140:143]
    s_waitcnt lgkmcnt(0)
    v_mfma_f32_16x16x32_bf16 v[144:147], a[176:179], a[4:7], 0
    ds_read_b64_tr_b16 a[184:185], v17 offset:64
    v_mfma_f32_16x16x32_bf16 v[144:147], a[180:183], a[8:11], v[144:147]
    buffer_load_dwordx4 v14, s[20:23], s41 offen offset:2048 lds
    v_mfma_f32_16x16x32_bf16 v[148:151], a[180:183], a[12:15], 0
    ds_read_b64_tr_b16 a[186:187], v17 offset:2368
    v_mfma_f32_16x16x32_bf16 v[148:151], a[176:179], a[8:11], v[148:151]
    ds_read_b64_tr_b16 a[188:189], v17 offset:9280
    v_mfma_f32_16x16x32_bf16 v[148:151], a[172:175], a[4:7], v[148:151]
    v_mfma_f32_16x16x32_bf16 v[152:155], a[172:175], a[8:11], 0
    buffer_load_dwordx4 v15, s[20:23], s41 offen offset:3072 lds
    v_mfma_f32_16x16x32_bf16 v[152:155], a[176:179], a[12:15], v[152:155]
    ds_read_b64_tr_b16 a[190:191], v17 offset:11584
    v_mfma_f32_16x16x32_bf16 v[152:155], a[180:183], a[16:19], v[152:155]
    s_add_u32 m0, s45, 0
    ds_read_b64_tr_b16 a[192:193], v17 offset:18496
    v_mfma_f32_16x16x32_bf16 v[156:159], a[180:183], a[20:23], 0
    buffer_load_dwordx4 v1, s[24:27], s40 offen offset:0 lds
    v_mfma_f32_16x16x32_bf16 v[156:159], a[176:179], a[16:19], v[156:159]
    ds_read_b64_tr_b16 a[194:195], v17 offset:20800
    v_mfma_f32_16x16x32_bf16 v[156:159], a[172:175], a[12:15], v[156:159]
    v_mfma_f32_16x16x32_bf16 v[160:163], a[172:175], a[16:19], 0
    ds_read_b128 a[56:59], v19 offset:3072
    v_mfma_f32_16x16x32_bf16 v[160:163], a[176:179], a[20:23], v[160:163]
    buffer_load_dwordx4 v2, s[24:27], s40 offen offset:1024 lds
    v_mfma_f32_16x16x32_bf16 v[160:163], a[180:183], a[24:27], v[160:163]
    ds_read_b128 a[60:63], v19 offset:4096
    v_mfma_f32_16x16x32_bf16 v[164:167], a[180:183], a[28:31], 0
    ds_read_b128 a[64:67], v19 offset:5120
    v_mfma_f32_16x16x32_bf16 v[164:167], a[176:179], a[24:27], v[164:167]
    v_mfma_f32_16x16x32_bf16 v[164:167], a[172:175], a[20:23], v[164:167]
    buffer_load_dwordx4 v3, s[24:27], s40 offen offset:2048 lds
    v_mfma_f32_16x16x32_bf16 v[168:171], a[172:175], a[24:27], 0
    v_mfma_f32_16x16x32_bf16 v[168:171], a[176:179], a[28:31], v[168:171]
    v_mfma_f32_16x16x32_bf16 v[168:171], a[180:183], a[32:35], v[168:171]
    v_mfma_f32_16x16x32_bf16 v[172:175], a[180:183], a[36:39], 0
    buffer_load_dwordx4 v4, s[24:27], s40 offen offset:3072 lds
    v_mfma_f32_16x16x32_bf16 v[172:175], a[176:179], a[32:35], v[172:175]
    v_mfma_f32_16x16x32_bf16 v[172:175], a[172:175], a[28:31], v[172:175]
    s_waitcnt lgkmcnt(0)
    v_mfma_f32_16x16x32_bf16 v[176:179], a[188:191], a[4:7], 0
    s_add_u32 m0, s45, 4096
    ds_read_b64_tr_b16 a[196:197], v17 offset:96
    v_mfma_f32_16x16x32_bf16 v[176:179], a[192:195], a[8:11], v[176:179]
    buffer_load_dwordx4 v5, s[24:27], s40 offen offset:0 lds
    ds_read_b64_tr_b16 a[198:199], v17 offset:2400
    v_mfma_f32_16x16x32_bf16 v[180:183], a[192:195], a[12:15], 0
    ds_read_b64_tr_b16 a[200:201], v17 offset:9312
    v_mfma_f32_16x16x32_bf16 v[180:183], a[188:191], a[8:11], v[180:183]
    ds_read_b64_tr_b16 a[202:203], v17 offset:11616
    v_mfma_f32_16x16x32_bf16 v[180:183], a[184:187], a[4:7], v[180:183]
    ds_read_b64_tr_b16 a[204:205], v17 offset:18528
    v_mfma_f32_16x16x32_bf16 v[184:187], a[184:187], a[8:11], 0
    buffer_load_dwordx4 v6, s[24:27], s40 offen offset:1024 lds
    ds_read_b64_tr_b16 a[206:207], v17 offset:20832
    v_mfma_f32_16x16x32_bf16 v[184:187], a[188:191], a[12:15], v[184:187]
    ds_read_b64_tr_b16 a[208:209], v21 offset:0
    v_mfma_f32_16x16x32_bf16 v[184:187], a[192:195], a[16:19], v[184:187]
    ds_read_b64_tr_b16 a[210:211], v21 offset:2304
    v_mfma_f32_16x16x32_bf16 v[188:191], a[192:195], a[20:23], 0
    ds_read_b64_tr_b16 a[212:213], v21 offset:9216
    v_mfma_f32_16x16x32_bf16 v[188:191], a[188:191], a[16:19], v[188:191]
    buffer_load_dwordx4 v7, s[24:27], s40 offen offset:2048 lds
    ds_read_b64_tr_b16 a[214:215], v21 offset:11520
    v_mfma_f32_16x16x32_bf16 v[188:191], a[184:187], a[12:15], v[188:191]
    ds_read_b64_tr_b16 a[216:217], v21 offset:18432
    v_mfma_f32_16x16x32_bf16 v[192:195], a[184:187], a[16:19], 0
    ds_read_b64_tr_b16 a[218:219], v21 offset:20736
    v_mfma_f32_16x16x32_bf16 v[192:195], a[188:191], a[20:23], v[192:195]
    ds_read_b128 a[68:71], v19 offset:6144
    v_mfma_f32_16x16x32_bf16 v[192:195], a[192:195], a[24:27], v[192:195]
    ds_read_b128 a[72:75], v19 offset:7168
    v_mfma_f32_16x16x32_bf16 v[196:199], a[192:195], a[28:31], 0
    ds_read_b128 a[76:79], v19 offset:8192
    v_mfma_f32_16x16x32_bf16 v[196:199], a[188:191], a[24:27], v[196:199]
    s_lshl_b32 s55, s56, 1
    v_mfma_f32_16x16x32_bf16 v[196:199], a[184:187], a[20:23], v[196:199]
    global_load_dword v23, v52, s[58:59]
    s_mov_b32 s45, s42
    s_add_u32 s42, s42, 27648
    v_mfma_f32_16x16x32_bf16 v[200:203], a[184:187], a[24:27], 0
    s_cmp_eq_u32 s42, 148480
    s_cselect_b32 s42, 65536, s42
    v_mfma_f32_16x16x32_bf16 v[200:203], a[188:191], a[28:31], v[200:203]
    s_add_u32 s40, s40, 36864
    v_add_u32 v17, s42, v16
    v_mfma_f32_16x16x32_bf16 v[200:203], a[192:195], a[32:35], v[200:203]
    v_add_u32 v21, s42, v20
    v_mfma_f32_16x16x32_bf16 v[204:207], a[192:195], a[36:39], 0
    s_add_u32 s41, s41, 128
    v_xor_b32 v18, 32768, v18
    v_mfma_f32_16x16x32_bf16 v[204:207], a[188:191], a[32:35], v[204:207]
    s_xor_b32 s43, s43, 32768
    v_xor_b32 v19, 32768, v19
    v_mfma_f32_16x16x32_bf16 v[204:207], a[184:187], a[28:31], v[204:207]
    s_waitcnt vmcnt(20) lgkmcnt(0)
    s_branch L_mid0
L_loop0:
    s_waitcnt lgkmcnt(0)
    v_mfma_f32_16x16x32_bf16 v[112:115], a[164:167], a[4:7], v[112:115]
    ds_read_b64_tr_b16 a[172:173], v17 offset:32
    v_mfma_f32_16x16x32_bf16 v[112:115], a[168:171], a[8:11], v[112:115]
    ds_read_b64_tr_b16 a[174:175], v17 offset:2336
    v_mfma_f32_16x16x32_bf16 v[116:119], a[168:171], a[12:15], v[116:119]
    v_mfma_f32_16x16x32_bf16 v[116:119], a[164:167], a[8:11], v[116:119]
    ds_read_b64_tr_b16 a[176:177], v17 offset:9248
    v_mfma_f32_16x16x32_bf16 v[116:119], a[160:163], a[4:7], v[116:119]
    v_mfma_f32_16x16x32_bf16 v[120:123], a[160:163], a[8:11], v[120:123]
    ds_read_b64_tr_b16 a[178:179], v17 offset:11552
    v_mfma_f32_16x16x32_bf16 v[120:123], a[164:167], a[12:15], v[120:123]
    s_cmp_lt_u32 s44, 7
    s_cselect_b32 s34, s34, 0
    v_mfma_f32_16x16x32_bf16 v[120:123], a[168:171], a[16:19], v[120:123]
    s_add_u32 s55, s55, s56
    ds_read_b64_tr_b16 a[180:181], v17 offset:18464
    v_mfma_f32_16x16x32_bf16 v[124:127], a[168:171], a[20:23], v[124:127]
    buffer_load_dword v23, v22, s[32:35], s55 offen
    v_mfma_f32_16x16x32_bf16 v[124:127], a[164:167], a[16:19], v[124:127]
    v_mfma_f32_16x16x32_bf16 v[124:127], a[160:163], a[12:15], v[124:127]
    ds_read_b64_tr_b16 a[182:183], v17 offset:20768
    v_mfma_f32_16x16x32_bf16 v[128:131], a[160:163], a[16:19], v[128:131]
    v_mfma_f32_16x16x32_bf16 v[128:131], a[164:167], a[20:23], v[128:131]
    ds_read_b128 a[44:47], v19 offset:0
    v_mfma_f32_16x16x32_bf16 v[128:131], a[168:171], a[24:27], v[128:131]
    ds_read_b128 a[48:51], v19 offset:1024
    v_mfma_f32_16x16x32_bf16 v[132:135], a[168:171], a[28:31], v[132:135]
    v_mfma_f32_16x16x32_bf16 v[132:135], a[164:167], a[24:27], v[132:135]
    ds_read_b128 a[52:55], v19 offset:2048
    v_mfma_f32_16x16x32_bf16 v[132:135], a[160:163], a[20:23], v[132:135]
    v_mfma_f32_16x16x32_bf16 v[136:139], a[160:163], a[24:27], v[136:139]
    v_mfma_f32_16x16x32_bf16 v[136:139], a[164:167], a[28:31], v[136:139]
    v_mfma_f32_16x16x32_bf16 v[136:139], a[168:171], a[32:35], v[136:139]
    v_mfma_f32_16x16x32_bf16 v[140:143], a[168:171], a[36:39], v[140:143]
    v_mfma_f32_16x16x32_bf16 v[140:143], a[164:167], a[32:35], v[140:143]
    v_mfma_f32_16x16x32_bf16 v[140:143], a[160:163], a[28:31], v[140:143]
    s_waitcnt lgkmcnt(0)
    v_mfma_f32_16x16x32_bf16 v[144:147], a[176:179], a[4:7], v[144:147]
    ds_read_b64_tr_b16 a[184:185], v17 offset:64
    v_mfma_f32_16x16x32_bf16 v[144:147], a[180:183], a[8:11], v[144:147]
    ds_read_b64_tr_b16 a[186:187], v17 offset:2368
    v_mfma_f32_16x16x32_bf16 v[148:151], a[180:183], a[12:15], v[148:151]
    v_mfma_f32_16x16x32_bf16 v[148:151], a[176:179], a[8:11], v[148:151]
    ds_read_b64_tr_b16 a[188:189], v17 offset:9280
    v_mfma_f32_16x16x32_bf16 v[148:151], a[172:175], a[4:7], v[148:151]
    v_mfma_f32_16x16x32_bf16 v[152:155], a[172:175], a[8:11], v[152:155]
    ds_read_b64_tr_b16 a[190:191], v17 offset:11584
    v_mfma_f32_16x16x32_bf16 v[152:155], a[176:179], a[12:15], v[152:155]
    v_mfma_f32_16x16x32_bf16 v[152:155], a[180:183], a[16:19], v[152:155]
    ds_read_b64_tr_b16 a[192:193], v17 offset:18496
    v_mfma_f32_16x16x32_bf16 v[156:159], a[180:183], a[20:23], v[156:159]
    v_mfma_f32_16x16x32_bf16 v[156:159], a[176:179], a[16:19], v[156:159]
    ds_read_b64_tr_b16 a[194:195], v17 offset:20800
    v_mfma_f32_16x16x32_bf16 v[156:159], a[172:175], a[12:15], v[156:159]
    v_mfma_f32_16x16x32_bf16 v[160:163], a[172:175], a[16:19], v[160:163]
    ds_read_b128 a[56:59], v19 offset:3072
    v_mfma_f32_16x16x32_bf16 v[160:163], a[176:179], a[20:23], v[160:163]
    v_mfma_f32_16x16x32_bf16 v[160:163], a[180:183], a[24:27], v[160:163]
    ds_read_b128 a[60:63], v19 offset:4096
    v_mfma_f32_16x16x32_bf16 v[164:167], a[180:183], a[28:31], v[164:167]
    v_mfma_f32_16x16x32_bf16 v[164:167], a[176:179], a[24:27], v[164:167]
    ds_read_b128 a[64:67], v19 offset:5120
    v_mfma_f32_16x16x32_bf16 v[164:167], a[172:175], a[20:23], v[164:167]
    v_mfma_f32_16x16x32_bf16 v[168:171], a[172:175], a[24:27], v[168:171]
    v_mfma_f32_16x16x32_bf16 v[168:171], a[176:179], a[28:31], v[168:171]
    v_mfma_f32_16x16x32_bf16 v[168:171], a[180:183], a[32:35], v[168:171]
    v_mfma_f32_16x16x32_bf16 v[172:175], a[180:183], a[36:39], v[172:175]
    v_mfma_f32_16x16x32_bf16 v[172:175], a[176:179], a[32:35], v[172:175]
    v_mfma_f32_16x16x32_bf16 v[172:175], a[172:175], a[28:31], v[172:175]
    s_waitcnt lgkmcnt(0)
    v_mfma_f32_16x16x32_bf16 v[176:179], a[188:191], a[4:7], v[176:179]
    ds_read_b64_tr_b16 a[196:197], v17 offset:96
    v_mfma_f32_16x16x32_bf16 v[176:179], a[192:195], a[8:11], v[176:179]
    ds_read_b64_tr_b16 a[198:199], v17 offset:2400
    v_mfma_f32_16x16x32_bf16 v[180:183], a[192:195], a[12:15], v[180:183]
    ds_read_b64_tr_b16 a[200:201], v17 offset:9312
    v_mfma_f32_16x16x32_bf16 v[180:183], a[188:191], a[8:11], v[180:183]
    ds_read_b64_tr_b16 a[202:203], v17 offset:11616
    v_mfma_f32_16x16x32_bf16 v[180:183], a[184:187], a[4:7], v[180:183]
    ds_read_b64_tr_b16 a[204:205], v17 offset:18528
    v_mfma_f32_16x16x32_bf16 v[184:187], a[184:187], a[8:11], v[184:187]
    ds_read_b64_tr_b16 a[206:207], v17 offset:20832
    v_mfma_f32_16x16x32_bf16 v[184:187], a[188:191], a[12:15], v[184:187]
    ds_read_b64_tr_b16 a[208:209], v21 offset:0
    v_mfma_f32_16x16x32_bf16 v[184:187], a[192:195], a[16:19], v[184:187]
    ds_read_b64_tr_b16 a[210:211], v21 offset:2304
    v_mfma_f32_16x16x32_bf16 v[188:191], a[192:195], a[20:23], v[188:191]
    ds_read_b64_tr_b16 a[212:213], v21 offset:9216
    v_mfma_f32_16x16x32_bf16 v[188:191], a[188:191], a[16:19], v[188:191]
    ds_read_b64_tr_b16 a[214:215], v21 offset:11520
    v_mfma_f32_16x16x32_bf16 v[188:191], a[184:187], a[12:15], v[188:191]
    ds_read_b64_tr_b16 a[216:217], v21 offset:18432
    v_mfma_f32_16x16x32_bf16 v[192:195], a[184:187], a[16:19], v[192:195]
    ds_read_b64_tr_b16 a[218:219], v21 offset:20736
    v_mfma_f32_16x16x32_bf16 v[192:195], a[188:191], a[20:23], v[192:195]
    ds_read_b128 a[68:71], v19 offset:6144
    v_mfma_f32_16x16x32_bf16 v[192:195], a[192:195], a[24:27], v[192:195]
    ds_read_b128 a[72:75], v19 offset:7168
    v_mfma_f32_16x16x32_bf16 v[196:199], a[192:195], a[28:31], v[196:199]
    ds_read_b128 a[76:79], v19 offset:8192
    v_mfma_f32_16x16x32_bf16 v[196:199], a[188:191], a[24:27], v[196:199]
    v_mfma_f32_16x16x32_bf16 v[196:199], a[184:187], a[20:23], v[196:199]
    s_mov_b32 s45, s42
    s_add_u32 s42, s42, 27648
    v_mfma_f32_16x16x32_bf16 v[200:203], a[184:187], a[24:27], v[200:203]
    s_cmp_eq_u32 s42, 148480
    s_cselect_b32 s42, 65536, s42
    v_mfma_f32_16x16x32_bf16 v[200:203], a[188:191], a[28:31], v[200:203]
    s_add_u32 s40, s40, 36864
    v_add_u32 v17, s42, v16
    v_mfma_f32_16x16x32_bf16 v[200:203], a[192:195], a[32:35], v[200:203]
    v_add_u32 v21, s42, v20
    v_mfma_f32_16x16x32_bf16 v[204:207], a[192:195], a[36:39], v[204:207]
    s_add_u32 s41, s41, 128
    v_xor_b32 v18, 32768, v18
    v_mfma_f32_16x16x32_bf16 v[204:207], a[188:191], a[32:35], v[204:207]
    s_xor_b32 s43, s43, 32768
    v_xor_b32 v19, 32768, v19
    v_mfma_f32_16x16x32_bf16 v[204:207], a[184:187], a[28:31], v[204:207]
    s_waitcnt vmcnt(16) lgkmcnt(0)
L_mid0:
    s_barrier
    v_mfma_f32_16x16x32_bf16 v[208:211], a[200:203], a[4:7], v[208:211]
    s_add_u32 m0, s45, 0
    ds_read_b64_tr_b16 a[160:161], v17 offset:0
    v_mfma_f32_16x16x32_bf16 v[208:211], a[204:207], a[8:11], v[208:211]
    buffer_load_dwordx4 v1, s[24:27], s40 offen offset:0 lds
    v_mfma_f32_16x16x32_bf16 v[212:215], a[204:207], a[12:15], v[212:215]
    v_mfma_f32_16x16x32_bf16 v[212:215], a[200:203], a[8:11], v[212:215]
    v_mfma_f32_16x16x32_bf16 v[212:215], a[196:199], a[4:7], v[212:215]
    ds_read_b64_tr_b16 a[162:163], v17 offset:2304
    v_mfma_f32_16x16x32_bf16 v[216:219], a[196:199], a[8:11], v[216:219]
    buffer_load_dwordx4 v2, s[24:27], s40 offen offset:1024 lds
    v_mfma_f32_16x16x32_bf16 v[216:219], a[200:203], a[12:15], v[216:219]
    v_mfma_f32_16x16x32_bf16 v[216:219], a[204:207], a[16:19], v[216:219]
    v_mfma_f32_16x16x32_bf16 v[220:223], a[204:207], a[20:23], v[220:223]
    ds_read_b64_tr_b16 a[164:165], v17 offset:9216
    v_mfma_f32_16x16x32_bf16 v[220:223], a[200:203], a[16:19], v[220:223]
    buffer_load_dwordx4 v3, s[24:27], s40 offen offset:2048 lds
    v_mfma_f32_16x16x32_bf16 v[220:223], a[196:199], a[12:15], v[220:223]
    v_mfma_f32_16x16x32_bf16 v[224:227], a[196:199], a[16:19], v[224:227]
    v_mfma_f32_16x16x32_bf16 v[224:227], a[200:203], a[20:23], v[224:227]
    ds_read_b64_tr_b16 a[166:167], v17 offset:11520
    v_mfma_f32_16x16x32_bf16 v[224:227], a[204:207], a[24:27], v[224:227]
    buffer_load_dwordx4 v4, s[24:27], s40 offen offset:3072 lds
    v_mfma_f32_16x16x32_bf16 v[228:231], a[204:207], a[28:31], v[228:231]
    v_mfma_f32_16x16x32_bf16 v[228:231], a[200:203], a[24:27], v[228:231]
    v_mfma_f32_16x16x32_bf16 v[228:231], a[196:199], a[20:23], v[228:231]
    s_add_u32 m0, s45, 4096
    ds_read_b64_tr_b16 a[168:169], v17 offset:18432
    v_mfma_f32_16x16x32_bf16 v[232:235], a[196:199], a[24:27], v[232:235]
    buffer_load_dwordx4 v5, s[24:27], s40 offen offset:0 lds
    v_mfma_f32_16x16x32_bf16 v[232:235], a[200:203], a[28:31], v[232:235]
    v_mfma_f32_16x16x32_bf16 v[232:235], a[204:207], a[32:35], v[232:235]
    v_mfma_f32_16x16x32_bf16 v[236:239], a[204:207], a[36:39], v[236:239]
    ds_read_b64_tr_b16 a[170:171], v17 offset:20736
    v_mfma_f32_16x16x32_bf16 v[236:239], a[200:203], a[32:35], v[236:239]
    buffer_load_dwordx4 v6, s[24:27], s40 offen offset:1024 lds
    v_mfma_f32_16x16x32_bf16 v[236:239], a[196:199], a[28:31], v[236:239]
    v_mfma_f32_16x16x32_bf16 v[240:243], a[212:215], a[4:7], v[240:243]
    v_mfma_f32_16x16x32_bf16 v[240:243], a[216:219], a[8:11], v[240:243]
    v_mfma_f32_16x16x32_bf16 v[244:247], a[216:219], a[12:15], v[244:247]
    buffer_load_dwordx4 v7, s[24:27], s40 offen offset:2048 lds
    v_mfma_f32_16x16x32_bf16 v[244:247], a[212:215], a[8:11], v[244:247]
    v_mfma_f32_16x16x32_bf16 v[244:247], a[208:211], a[4:7], v[244:247]
    v_mfma_f32_16x16x32_bf16 v[248:251], a[208:211], a[8:11], v[248:251]
    v_mfma_f32_16x16x32_bf16 v[248:251], a[212:215], a[12:15], v[248:251]
    v_mfma_f32_16x16x32_bf16 v[248:251], a[216:219], a[16:19], v[248:251]
    v_mfma_f32_16x16x32_bf16 v[252:255], a[216:219], a[20:23], v[252:255]
    v_mfma_f32_16x16x32_bf16 v[252:255], a[212:215], a[16:19], v[252:255]
    v_mfma_f32_16x16x32_bf16 v[252:255], a[208:211], a[12:15], v[252:255]
    s_waitcnt lgkmcnt(0)
    v_mfma_f32_16x16x32_bf16 v[112:115], a[164:167], a[44:47], v[112:115]
    ds_read_b64_tr_b16 a[172:173], v17 offset:32
    v_mfma_f32_16x16x32_bf16 v[112:115], a[168:171], a[48:51], v[112:115]
    s_add_u32 m0, s43, 0
    v_mfma_f32_16x16x32_bf16 v[116:119], a[168:171], a[52:55], v[116:119]
    buffer_load_dwordx4 v8, s[20:23], s41 offen offset:0 lds
    v_mfma_f32_16x16x32_bf16 v[116:119], a[164:167], a[48:51], v[116:119]
    ds_read_b64_tr_b16 a[174:175], v17 offset:2336
    v_mfma_f32_16x16x32_bf16 v[116:119], a[160:163], a[44:47], v[116:119]
    v_mfma_f32_16x16x32_bf16 v[120:123], a[160:163], a[48:51], v[120:123]
    ds_read_b64_tr_b16 a[176:177], v17 offset:9248
    v_mfma_f32_16x16x32_bf16 v[120:123], a[164:167], a[52:55], v[120:123]
    v_mfma_f32_16x16x32_bf16 v[120:123], a[168:171], a[56:59], v[120:123]
    v_mfma_f32_16x16x32_bf16 v[124:127], a[168:171], a[60:63], v[124:127]
    buffer_load_dwordx4 v9, s[20:23], s41 offen offset:1024 lds
    v_mfma_f32_16x16x32_bf16 v[124:127], a[164:167], a[56:59], v[124:127]
    ds_read_b64_tr_b16 a[178:179], v17 offset:11552
    v_mfma_f32_16x16x32_bf16 v[124:127], a[160:163], a[52:55], v[124:127]
    v_mfma_f32_16x16x32_bf16 v[128:131], a[160:163], a[56:59], v[128:131]
    ds_read_b64_tr_b16 a[180:181], v17 offset:18464
    v_mfma_f32_16x16x32_bf16 v[128:131], a[164:167], a[60:63], v[128:131]
    v_mfma_f32_16x16x32_bf16 v[128:131], a[168:171], a[64:67], v[128:131]
    ds_read_b64_tr_b16 a[182:183], v17 offset:20768
    v_mfma_f32_16x16x32_bf16 v[132:135], a[168:171], a[68:71], v[132:135]
    buffer_load_dwordx4 v10, s[20:23], s41 offen offset:2048 lds
    v_mfma_f32_16x16x32_bf16 v[132:135], a[164:167], a[64:67], v[132:135]
    v_mfma_f32_16x16x32_bf16 v[132:135], a[160:163], a[60:63], v[132:135]
    v_mfma_f32_16x16x32_bf16 v[136:139], a[160:163], a[64:67], v[136:139]
    v_mfma_f32_16x16x32_bf16 v[136:139], a[164:167], a[68:71], v[136:139]
    v_mfma_f32_16x16x32_bf16 v[136:139], a[168:171], a[72:75], v[136:139]
    v_mfma_f32_16x16x32_bf16 v[140:143], a[168:171], a[76:79], v[140:143]
    buffer_load_dwordx4 v11, s[20:23], s41 offen offset:3072 lds
    v_mfma_f32_16x16x32_bf16 v[140:143], a[164:167], a[72:75], v[140:143]
    v_mfma_f32_16x16x32_bf16 v[140:143], a[160:163], a[68:71], v[140:143]
    s_waitcnt lgkmcnt(0)
    v_mfma_f32_16x16x32_bf16 v[144:147], a[176:179], a[44:47], v[144:147]
    ds_read_b64_tr_b16 a[184:185], v17 offset:64
    v_mfma_f32_16x16x32_bf16 v[144:147], a[180:183], a[48:51], v[144:147]
    v_mfma_f32_16x16x32_bf16 v[148:151], a[180:183], a[52:55], v[148:151]
    s_add_u32 m0, s43, 16384
    ds_read_b64_tr_b16 a[186:187], v17 offset:2368
    v_mfma_f32_16x16x32_bf16 v[148:151], a[176:179], a[48:51], v[148:151]
    buffer_load_dwordx4 v12, s[20:23], s41 offen offset:0 lds
    v_mfma_f32_16x16x32_bf16 v[148:151], a[172:175], a[44:47], v[148:151]
    v_mfma_f32_16x16x32_bf16 v[152:155], a[172:175], a[48:51], v[152:155]
    ds_read_b64_tr_b16 a[188:189], v17 offset:9280
    v_mfma_f32_16x16x32_bf16 v[152:155], a[176:179], a[52:55], v[152:155]
    v_mfma_f32_16x16x32_bf16 v[152:155], a[180:183], a[56:59], v[152:155]
    v_mfma_f32_16x16x32_bf16 v[156:159], a[180:183], a[60:63], v[156:159]
    ds_read_b64_tr_b16 a[190:191], v17 offset:11584
    v_mfma_f32_16x16x32_bf16 v[156:159], a[176:179], a[56:59], v[156:159]
    buffer_load_dwordx4 v13, s[20:23], s41 offen offset:1024 lds
    v_mfma_f32_16x16x32_bf16 v[156:159], a[172:175], a[52:55], v[156:159]
    v_mfma_f32_16x16x32_bf16 v[160:163], a[172:175], a[56:59], v[160:163]
    ds_read_b64_tr_b16 a[192:193], v17 offset:18496
    v_mfma_f32_16x16x32_bf16 v[160:163], a[176:179], a[60:63], v[160:163]
    v_mfma_f32_16x16x32_bf16 v[160:163], a[180:183], a[64:67], v[160:163]
    ds_read_b64_tr_b16 a[194:195], v17 offset:20800
    v_mfma_f32_16x16x32_bf16 v[164:167], a[180:183], a[68:71], v[164:167]
    v_mfma_f32_16x16x32_bf16 v[164:167], a[176:179], a[64:67], v[164:167]
    buffer_load_dwordx4 v14, s[20:23], s41 offen offset:2048 lds
    v_mfma_f32_16x16x32_bf16 v[164:167], a[172:175], a[60:63], v[164:167]
    v_mfma_f32_16x16x32_bf16 v[168:171], a[172:175], a[64:67], v[168:171]
    v_mfma_f32_16x16x32_bf16 v[168:171], a[176:179], a[68:71], v[168:171]
    v_mfma_f32_16x16x32_bf16 v[168:171], a[180:183], a[72:75], v[168:171]
    v_mfma_f32_16x16x32_bf16 v[172:175], a[180:183], a[76:79], v[172:175]
    v_mfma_f32_16x16x32_bf16 v[172:175], a[176:179], a[72:75], v[172:175]
    buffer_load_dwordx4 v15, s[20:23], s41 offen offset:3072 lds
    v_mfma_f32_16x16x32_bf16 v[172:175], a[172:175], a[68:71], v[172:175]
    s_waitcnt lgkmcnt(0)
    v_mfma_f32_16x16x32_bf16 v[176:179], a[188:191], a[44:47], v[176:179]
    ds_read_b64_tr_b16 a[196:197], v17 offset:96
    v_mfma_f32_16x16x32_bf16 v[176:179], a[192:195], a[48:51], v[176:179]
    ds_read_b64_tr_b16 a[198:199], v17 offset:2400
    v_mfma_f32_16x16x32_bf16 v[180:183], a[192:195], a[52:55], v[180:183]
    ds_read_b64_tr_b16 a[200:201], v17 offset:9312
    v_mfma_f32_16x16x32_bf16 v[180:183], a[188:191], a[48:51], v[180:183]
    v_mfma_f32_16x16x32_bf16 v[180:183], a[184:187], a[44:47], v[180:183]
    ds_read_b64_tr_b16 a[202:203], v17 offset:11616
    v_mfma_f32_16x16x32_bf16 v[184:187], a[184:187], a[48:51], v[184:187]
    ds_read_b64_tr_b16 a[204:205], v17 offset:18528
    v_mfma_f32_16x16x32_bf16 v[184:187], a[188:191], a[52:55], v[184:187]
    ds_read_b64_tr_b16 a[206:207], v17 offset:20832
    v_mfma_f32_16x16x32_bf16 v[184:187], a[192:195], a[56:59], v[184:187]
    v_mfma_f32_16x16x32_bf16 v[188:191], a[192:195], a[60:63], v[188:191]
    ds_read_b64_tr_b16 a[208:209], v21 offset:0
    v_mfma_f32_16x16x32_bf16 v[188:191], a[188:191], a[56:59], v[188:191]
    ds_read_b64_tr_b16 a[210:211], v21 offset:2304
    v_mfma_f32_16x16x32_bf16 v[188:191], a[184:187], a[52:55], v[188:191]
    ds_read_b64_tr_b16 a[212:213], v21 offset:9216
    v_mfma_f32_16x16x32_bf16 v[192:195], a[184:187], a[56:59], v[192:195]
    v_mfma_f32_16x16x32_bf16 v[192:195], a[188:191], a[60:63], v[192:195]
    ds_read_b64_tr_b16 a[214:215], v21 offset:11520
    v_mfma_f32_16x16x32_bf16 v[192:195], a[192:195], a[64:67], v[192:195]
    ds_read_b64_tr_b16 a[216:217], v21 offset:18432
    v_mfma_f32_16x16x32_bf16 v[196:199], a[192:195], a[68:71], v[196:199]
    ds_read_b64_tr_b16 a[218:219], v21 offset:20736
    v_mfma_f32_16x16x32_bf16 v[196:199], a[188:191], a[64:67], v[196:199]
    v_mfma_f32_16x16x32_bf16 v[196:199], a[184:187], a[60:63], v[196:199]
    s_mov_b32 s45, s42
    s_add_u32 s42, s42, 27648
    v_mfma_f32_16x16x32_bf16 v[200:203], a[184:187], a[64:67], v[200:203]
    s_cmp_eq_u32 s42, 148480
    s_cselect_b32 s42, 65536, s42
    v_mfma_f32_16x16x32_bf16 v[200:203], a[188:191], a[68:71], v[200:203]
    s_add_u32 s40, s40, 36864
    v_add_u32 v17, s42, v16
    v_mfma_f32_16x16x32_bf16 v[200:203], a[192:195], a[72:75], v[200:203]
    v_add_u32 v21, s42, v20
    v_mfma_f32_16x16x32_bf16 v[204:207], a[192:195], a[76:79], v[204:207]
    v_mfma_f32_16x16x32_bf16 v[204:207], a[188:191], a[72:75], v[204:207]
    v_mfma_f32_16x16x32_bf16 v[204:207], a[184:187], a[68:71], v[204:207]
    s_waitcnt vmcnt(16) lgkmcnt(0)
    s_barrier
    v_mfma_f32_16x16x32_bf16 v[208:211], a[200:203], a[44:47], v[208:211]
    s_add_u32 m0, s45, 0
    ds_read_b64_tr_b16 a[160:161], v17 offset:0
    v_mfma_f32_16x16x32_bf16 v[208:211], a[204:207], a[48:51], v[208:211]
    buffer_load_dwordx4 v1, s[24:27], s40 offen offset:0 lds
    v_mfma_f32_16x16x32_bf16 v[212:215], a[204:207], a[52:55], v[212:215]
    ds_read_b64_tr_b16 a[162:163], v17 offset:2304
    v_mfma_f32_16x16x32_bf16 v[212:215], a[200:203], a[48:51], v[212:215]
    ds_read_b64_tr_b16 a[164:165], v17 offset:9216
    v_mfma_f32_16x16x32_bf16 v[212:215], a[196:199], a[44:47], v[212:215]
    ds_read_b64_tr_b16 a[166:167], v17 offset:11520
    v_mfma_f32_16x16x32_bf16 v[216:219], a[196:199], a[48:51], v[216:219]
    buffer_load_dwordx4 v2, s[24:27], s40 offen offset:1024 lds
    v_mfma_f32_16x16x32_bf16 v[216:219], a[200:203], a[52:55], v[216:219]
    ds_read_b64_tr_b16 a[168:169], v17 offset:18432
    v_mfma_f32_16x16x32_bf16 v[216:219], a[204:207], a[56:59], v[216:219]
    v_mfma_f32_16x16x32_bf16 v[220:223], a[204:207], a[60:63], v[220:223]
    ds_read_b64_tr_b16 a[170:171], v17 offset:20736
    v_mfma_f32_16x16x32_bf16 v[220:223], a[200:203], a[56:59], v[220:223]
    buffer_load_dwordx4 v3, s[24:27], s40 offen offset:2048 lds
    v_mfma_f32_16x16x32_bf16 v[220:223], a[196:199], a[52:55], v[220:223]
    ds_read_b128 a[4:7], v18 offset:0
    v_mfma_f32_16x16x32_bf16 v[224:227], a[196:199], a[56:59], v[224:227]
    ds_read_b128 a[8:11], v18 offset:1024
    v_mfma_f32_16x16x32_bf16 v[224:227], a[200:203], a[60:63], v[224:227]
    ds_read_b128 a[12:15], v18 offset:2048
    v_mfma_f32_16x16x32_bf16 v[224:227], a[204:207], a[64:67], v[224:227]
    buffer_load_dwordx4 v4, s[24:27], s40 offen offset:3072 lds
    v_mfma_f32_16x16x32_bf16 v[228:231], a[204:207], a[68:71], v[228:231]
    ds_read_b128 a[16:19], v18 offset:3072
    v_mfma_f32_16x16x32_bf16 v[228:231], a[200:203], a[64:67], v[228:231]
    v_mfma_f32_16x16x32_bf16 v[228:231], a[196:199], a[60:63], v[228:231]
    s_add_u32 m0, s45, 4096
    ds_read_b128 a[20:23], v18 offset:4096
    v_mfma_f32_16x16x32_bf16 v[232:235], a[196:199], a[64:67], v[232:235]
    buffer_load_dwordx4 v5, s[24:27], s40 offen offset:0 lds
    v_mfma_f32_16x16x32_bf16 v[232:235], a[200:203], a[68:71], v[232:235]
    ds_read_b128 a[24:27], v18 offset:5120
    v_mfma_f32_16x16x32_bf16 v[232:235], a[204:207], a[72:75], v[232:235]
    ds_read_b128 a[28:31], v18 offset:6144
    v_mfma_f32_16x16x32_bf16 v[236:239], a[204:207], a[76:79], v[236:239]
    ds_read_b128 a[32:35], v18 offset:7168
    v_mfma_f32_16x16x32_bf16 v[236:239], a[200:203], a[72:75], v[236:239]
    buffer_load_dwordx4 v6, s[24:27], s40 offen offset:1024 lds
    v_mfma_f32_16x16x32_bf16 v[236:239], a[196:199], a[68:71], v[236:239]
    ds_read_b128 a[36:39], v18 offset:8192
    v_mfma_f32_16x16x32_bf16 v[240:243], a[212:215], a[44:47], v[240:243]
    v_mfma_f32_16x16x32_bf16 v[240:243], a[216:219], a[48:51], v[240:243]
    v_mfma_f32_16x16x32_bf16 v[244:247], a[216:219], a[52:55], v[244:247]
    buffer_load_dwordx4 v7, s[24:27], s40 offen offset:2048 lds
    v_mfma_f32_16x16x32_bf16 v[244:247], a[212:215], a[48:51], v[244:247]
    v_mfma_f32_16x16x32_bf16 v[244:247], a[208:211], a[44:47], v[244:247]
    v_mfma_f32_16x16x32_bf16 v[248:251], a[208:211], a[48:51], v[248:251]
    v_mfma_f32_16x16x32_bf16 v[248:251], a[212:215], a[52:55], v[248:251]
    v_mfma_f32_16x16x32_bf16 v[248:251], a[216:219], a[56:59], v[248:251]
    v_mfma_f32_16x16x32_bf16 v[252:255], a[216:219], a[60:63], v[252:255]
    v_mfma_f32_16x16x32_bf16 v[252:255], a[212:215], a[56:59], v[252:255]
    s_add_u32 s44, s44, 1
    s_cmp_eq_u32 s44, 7
    v_mfma_f32_16x16x32_bf16 v[252:255], a[208:211], a[52:55], v[252:255]
    s_cbranch_scc0 L_loop0
    s_branch L_tail
.if (. - L_w0) > 4096
.error "variant page overflow"
.endif
.p2align 12
L_w1:
    s_cbranch_vccnz L_backA
    s_waitcnt vmcnt(11)
    s_barrier
    ds_read_b64_tr_b16 a[164:165], v17 offset:9216
    ds_read_b64_tr_b16 a[166:167], v17 offset:11520
    ds_read_b128 a[4:7], v18 offset:0
    ds_read_b64_tr_b16 a[168:169], v17 offset:18432
    ds_read_b64_tr_b16 a[170:171], v17 offset:20736
    ds_read_b128 a[8:11], v18 offset:1024
    ds_read_b128 a[12:15], v18 offset:2048
    ds_read_b64_tr_b16 a[160:161], v17 offset:0
    ds_read_b64_tr_b16 a[162:163], v17 offset:2304
    ds_read_b128 a[16:19], v18 offset:3072
    ds_read_b128 a[20:23], v18 offset:4096
    ds_read_b128 a[24:27], v18 offset:5120
    ds_read_b128 a[28:31], v18 offset:6144
    ds_read_b128 a[32:35], v18 offset:7168
    ds_read_b128 a[36:39], v18 offset:8192
    s_waitcnt lgkmcnt(12)
    v_mfma_f32_16x16x32_bf16 v[112:115], a[164:167], a[4:7], 0
    s_add_u32 m0, s43, 4096
    s_waitcnt lgkmcnt(9)
    v_mfma_f32_16x16x32_bf16 v[112:115], a[168:171], a[8:11], v[112:115]
    buffer_load_dwordx4 v8, s[20:23], s41 offen offset:0 lds
    s_waitcnt lgkmcnt(8)
    v_mfma_f32_16x16x32_bf16 v[116:119], a[168:171], a[12:15], 0
    v_mfma_f32_16x16x32_bf16 v[116:119], a[164:167], a[8:11], v[116:119]
    ds_read_b64_tr_b16 a[172:173], v17 offset:32
    s_waitcnt lgkmcnt(7)
    v_mfma_f32_16x16x32_bf16 v[116:119], a[160:163], a[4:7], v[116:119]
    buffer_load_dwordx4 v9, s[20:23], s41 offen offset:1024 lds
    ds_read_b64_tr_b16 a[174:175], v17 offset:2336
    v_mfma_f32_16x16x32_bf16 v[120:123], a[160:163], a[8:11], 0
    v_mfma_f32_16x16x32_bf16 v[120:123], a[164:167], a[12:15], v[120:123]
    ds_read_b64_tr_b16 a[176:177], v17 offset:9248
    s_waitcnt lgkmcnt(7)
    v_mfma_f32_16x16x32_bf16 v[120:123], a[168:171], a[16:19], v[120:123]
    v_mfma_f32_16x16x32_bf16 v[124:127], a[168:171], a[20:23], 0
    buffer_load_dwordx4 v10, s[20:23], s41 offen offset:2048 lds
    ds_read_b64_tr_b16 a[178:179], v17 offset:11552
    v_mfma_f32_16x16x32_bf16 v[124:127], a[164:167], a[16:19], v[124:127]
    ds_read_b64_tr_b16 a[180:181], v17 offset:18464
    v_mfma_f32_16x16x32_bf16 v[124:127], a[160:163], a[12:15], v[124:127]
    ds_read_b64_tr_b16 a[182:183], v17 offset:20768
    v_mfma_f32_16x16x32_bf16 v[128:131], a[160:163], a[16:19], 0
    v_mfma_f32_16x16x32_bf16 v[128:131], a[164:167], a[20:23], v[128:131]
    buffer_load_dwordx4 v11, s[20:23], s41 offen offset:3072 lds
    ds_read_b128 a[44:47], v19 offset:0
    s_waitcnt lgkmcnt(7)
    v_mfma_f32_16x16x32_bf16 v[128:131], a[168:171], a[24:27], v[128:131]
    v_mfma_f32_16x16x32_bf16 v[132:135], a[168:171], a[28:31], 0
    ds_read_b128 a[48:51], v19 offset:1024
    v_mfma_f32_16x16x32_bf16 v[132:135], a[164:167], a[24:27], v[132:135]
    s_add_u32 m0, s43, 20480
    ds_read_b128 a[52:55], v19 offset:2048
    v_mfma_f32_16x16x32_bf16 v[132:135], a[160:163], a[20:23], v[132:135]
    buffer_load_dwordx4 v12, s[20:23], s41 offen offset:0 lds
    v_mfma_f32_16x16x32_bf16 v[136:139], a[160:163], a[24:27], 0
    v_mfma_f32_16x16x32_bf16 v[136:139], a[164:167], a[28:31], v[136:139]
    v_mfma_f32_16x16x32_bf16 v[136:139], a[168:171], a[32:35], v[136:139]
    v_mfma_f32_16x16x32_bf16 v[140:143], a[168:171], a[36:39], 0
    buffer_load_dwordx4 v13, s[20:23], s41 offen offset:1024 lds
    v_mfma_f32_16x16x32_bf16 v[140:143], a[164:167], a[32:35], v[140:143]
    v_mfma_f32_16x16x32_bf16 v[140:143], a[160:163], a[28:31], v[140:143]
    s_waitcnt lgkmcnt(0)
    v_mfma_f32_16x16x32_bf16 v[144:147], a[176:179], a[4:7], 0
    ds_read_b64_tr_b16 a[184:185], v17 offset:64
    v_mfma_f32_16x16x32_bf16 v[144:147], a[180:183], a[8:11], v[144:147]
    buffer_load_dwordx4 v14, s[20:23], s41 offen offset:2048 lds
    v_mfma_f32_16x16x32_bf16 v[148:151], a[180:183], a[12:15], 0
    ds_read_b64_tr_b16 a[186:187], v17 offset:2368
    v_mfma_f32_16x16x32_bf16 v[148:151], a[176:179], a[8:11], v[148:151]
    ds_read_b64_tr_b16 a[188:189], v17 offset:9280
    v_mfma_f32_16x16x32_bf16 v[148:151], a[172:175], a[4:7], v[148:151]
    v_mfma_f32_16x16x32_bf16 v[152:155], a[172:175], a[8:11], 0
    buffer_load_dwordx4 v15, s[20:23], s41 offen offset:3072 lds
    v_mfma_f32_16x16x32_bf16 v[152:155], a[176:179], a[12:15], v[152:155]
    ds_read_b64_tr_b16 a[190:191], v17 offset:11584
    v_mfma_f32_16x16x32_bf16 v[152:155], a[180:183], a[16:19], v[152:155]
    s_add_u32 m0, s45, 7168
    ds_read_b64_tr_b16 a[192:193], v17 offset:18496
    v_mfma_f32_16x16x32_bf16 v[156:159], a[180:183], a[20:23], 0
    buffer_load_dwordx4 v1, s[24:27], s40 offen offset:0 lds
    v_mfma_f32_16x16x32_bf16 v[156:159], a[176:179], a[16:19], v[156:159]
    ds_read_b64_tr_b16 a[194:195], v17 offset:20800
    v_mfma_f32_16x16x32_bf16 v[156:159], a[172:175], a[12:15], v[156:159]
    v_mfma_f32_16x16x32_bf16 v[160:163], a[172:175], a[16:19], 0
    ds_read_b128 a[56:59], v19 offset:3072
    v_mfma_f32_16x16x32_bf16 v[160:163], a[176:179], a[20:23], v[160:163]
    buffer_load_dwordx4 v2, s[24:27], s40 offen offset:1024 lds
    v_mfma_f32_16x16x32_bf16 v[160:163], a[180:183], a[24:27], v[160:163]
    ds_read_b128 a[60:63], v19 offset:4096
    v_mfma_f32_16x16x32_bf16 v[164:167], a[180:183], a[28:31], 0
    ds_read_b128 a[64:67], v19 offset:5120
    v_mfma_f32_16x16x32_bf16 v[164:167], a[176:179], a[24:27], v[164:167]
    v_mfma_f32_16x16x32_bf16 v[164:167], a[172:175], a[20:23], v[164:167]
    buffer_load_dwordx4 v3, s[24:27], s40 offen offset:2048 lds
    v_mfma_f32_16x16x32_bf16 v[168:171], a[172:175], a[24:27], 0
    v_mfma_f32_16x16x32_bf16 v[168:171], a[176:179], a[28:31], v[168:171]
    v_mfma_f32_16x16x32_bf16 v[168:171], a[180:183], a[32:35], v[168:171]
    v_mfma_f32_16x16x32_bf16 v[172:175], a[180:183], a[36:39], 0
    buffer_load_dwordx4 v4, s[24:27], s40 offen offset:3072 lds
    v_mfma_f32_16x16x32_bf16 v[172:175], a[176:179], a[32:35], v[172:175]
    v_mfma_f32_16x16x32_bf16 v[172:175], a[172:175], a[28:31], v[172:175]
    s_waitcnt lgkmcnt(0)
    v_mfma_f32_16x16x32_bf16 v[176:179], a[188:191], a[4:7], 0
    s_add_u32 m0, s45, 11264
    ds_read_b64_tr_b16 a[196:197], v17 offset:96
    v_mfma_f32_16x16x32_bf16 v[176:179], a[192:195], a[8:11], v[176:179]
    buffer_load_dwordx4 v5, s[24:27], s40 offen offset:0 lds
    ds_read_b64_tr_b16 a[198:199], v17 offset:2400
    v_mfma_f32_16x16x32_bf16 v[180:183], a[192:195], a[12:15], 0
    ds_read_b64_tr_b16 a[200:201], v17 offset:9312
    v_mfma_f32_16x16x32_bf16 v[180:183], a[188:191], a[8:11], v[180:183]
    ds_read_b64_tr_b16 a[202:203], v17 offset:11616
    v_mfma_f32_16x16x32_bf16 v[180:183], a[184:187], a[4:7], v[180:183]
    ds_read_b64_tr_b16 a[204:205], v17 offset:18528
    v_mfma_f32_16x16x32_bf16 v[184:187], a[184:187], a[8:11], 0
    buffer_load_dwordx4 v6, s[24:27], s40 offen offset:1024 lds
    ds_read_b64_tr_b16 a[206:207], v17 offset:20832
    v_mfma_f32_16x16x32_bf16 v[184:187], a[188:191], a[12:15], v[184:187]
    ds_read_b64_tr_b16 a[208:209], v21 offset:0
    v_mfma_f32_16x16x32_bf16 v[184:187], a[192:195], a[16:19], v[184:187]
    ds_read_b64_tr_b16 a[210:211], v21 offset:2304
    v_mfma_f32_16x16x32_bf16 v[188:191], a[192:195], a[20:23], 0
    ds_read_b64_tr_b16 a[212:213], v21 offset:9216
    v_mfma_f32_16x16x32_bf16 v[188:191], a[188:191], a[16:19], v[188:191]
    buffer_load_dwordx4 v7, s[24:27], s40 offen offset:2048 lds
    ds_read_b64_tr_b16 a[214:215], v21 offset:11520
    v_mfma_f32_16x16x32_bf16 v[188:191], a[184:187], a[12:15], v[188:191]
    ds_read_b64_tr_b16 a[216:217], v21 offset:18432
    v_mfma_f32_16x16x32_bf16 v[192:195], a[184:187], a[16:19], 0
    ds_read_b64_tr_b16 a[218:219], v21 offset:20736
    v_mfma_f32_16x16x32_bf16 v[192:195], a[188:191], a[20:23], v[192:195]
    ds_read_b128 a[68:71], v19 offset:6144
    v_mfma_f32_16x16x32_bf16 v[192:195], a[192:195], a[24:27], v[192:195]
    ds_read_b128 a[72:75], v19 offset:7168
    v_mfma_f32_16x16x32_bf16 v[196:199], a[192:195], a[28:31], 0
    ds_read_b128 a[76:79], v19 offset:8192
    v_mfma_f32_16x16x32_bf16 v[196:199], a[188:191], a[24:27], v[196:199]
    s_lshl_b32 s55, s56, 1
    v_mfma_f32_16x16x32_bf16 v[196:199], a[184:187], a[20:23], v[196:199]
    global_load_dword v23, v52, s[58:59]
    s_mov_b32 s45, s42
    s_add_u32 s42, s42, 27648
    v_mfma_f32_16x16x32_bf16 v[200:203], a[184:187], a[24:27], 0
    s_cmp_eq_u32 s42, 148480
    s_cselect_b32 s42, 65536, s42
    v_mfma_f32_16x16x32_bf16 v[200:203], a[188:191], a[28:31], v[200:203]
    s_add_u32 s40, s40, 36864
    v_add_u32 v17, s42, v16
    v_mfma_f32_16x16x32_bf16 v[200:203], a[192:195], a[32:35], v[200:203]
    v_add_u32 v21, s42, v20
    v_mfma_f32_16x16x32_bf16 v[204:207], a[192:195], a[36:39], 0
    s_add_u32 s41, s41, 128
    v_xor_b32 v18, 32768, v18
    v_mfma_f32_16x16x32_bf16 v[204:207], a[188:191], a[32:35], v[204:207]
    s_xor_b32 s43, s43, 32768
    v_xor_b32 v19, 32768, v19
    v_mfma_f32_16x16x32_bf16 v[204:207], a[184:187], a[28:31], v[204:207]
    s_waitcnt vmcnt(20) lgkmcnt(0)
    s_branch L_mid1
L_loop1:
    s_waitcnt lgkmcnt(0)
    v_mfma_f32_16x16x32_bf16 v[112:115], a[164:167], a[4:7], v[112:115]
    ds_read_b64_tr_b16 a[172:173], v17 offset:32
    v_mfma_f32_16x16x32_bf16 v[112:115], a[168:171], a[8:11], v[112:115]
    ds_read_b64_tr_b16 a[174:175], v17 offset:2336
    v_mfma_f32_16x16x32_bf16 v[116:119], a[168:171], a[12:15], v[116:119]
    v_mfma_f32_16x16x32_bf16 v[116:119], a[164:167], a[8:11], v[116:119]
    ds_read_b64_tr_b16 a[176:177], v17 offset:9248
    v_mfma_f32_16x16x32_bf16 v[116:119], a[160:163], a[4:7], v[116:119]
    v_mfma_f32_16x16x32_bf16 v[120:123], a[160:163], a[8:11], v[120:123]
    ds_read_b64_tr_b16 a[178:179], v17 offset:11552
    v_mfma_f32_16x16x32_bf16 v[120:123], a[164:167], a[12:15], v[120:123]
    s_cmp_lt_u32 s44, 7
    s_cselect_b32 s34, s34, 0
    v_mfma_f32_16x16x32_bf16 v[120:123], a[168:171], a[16:19], v[120:123]
    s_add_u32 s55, s55, s56
    ds_read_b64_tr_b16 a[180:181], v17 offset:18464
    v_mfma_f32_16x16x32_bf16 v[124:127], a[168:171], a[20:23], v[124:127]
    buffer_load_dword v23, v22, s[32:35], s55 offen
    v_mfma_f32_16x16x32_bf16 v[124:127], a[164:167], a[16:19], v[124:127]
    v_mfma_f32_16x16x32_bf16 v[124:127], a[160:163], a[12:15], v[124:127]
    ds_read_b64_tr_b16 a[182:183], v17 offset:20768
    v_mfma_f32_16x16x32_bf16 v[128:131], a[160:163], a[16:19], v[128:131]
    v_mfma_f32_16x16x32_bf16 v[128:131], a[164:167], a[20:23], v[128:131]
    ds_read_b128 a[44:47], v19 offset:0
    v_mfma_f32_16x16x32_bf16 v[128:131], a[168:171], a[24:27], v[128:131]
    ds_read_b128 a[48:51], v19 offset:1024
    v_mfma_f32_16x16x32_bf16 v[132:135], a[168:171], a[28:31], v[132:135]
    v_mfma_f32_16x16x32_bf16 v[132:135], a[164:167], a[24:27], v[132:135]
    ds_read_b128 a[52:55], v19 offset:2048
    v_mfma_f32_16x16x32_bf16 v[132:135], a[160:163], a[20:23], v[132:135]
    v_mfma_f32_16x16x32_bf16 v[136:139], a[160:163], a[24:27], v[136:139]
    v_mfma_f32_16x16x32_bf16 v[136:139], a[164:167], a[28:31], v[136:139]
    v_mfma_f32_16x16x32_bf16 v[136:139], a[168:171], a[32:35], v[136:139]
    v_mfma_f32_16x16x32_bf16 v[140:143], a[168:171], a[36:39], v[140:143]
    v_mfma_f32_16x16x32_bf16 v[140:143], a[164:167], a[32:35], v[140:143]
    v_mfma_f32_16x16x32_bf16 v[140:143], a[160:163], a[28:31], v[140:143]
    s_waitcnt lgkmcnt(0)
    v_mfma_f32_16x16x32_bf16 v[144:147], a[176:179], a[4:7], v[144:147]
    ds_read_b64_tr_b16 a[184:185], v17 offset:64
    v_mfma_f32_16x16x32_bf16 v[144:147], a[180:183], a[8:11], v[144:147]
    ds_read_b64_tr_b16 a[186:187], v17 offset:2368
    v_mfma_f32_16x16x32_bf16 v[148:151], a[180:183], a[12:15], v[148:151]
    v_mfma_f32_16x16x32_bf16 v[148:151], a[176:179], a[8:11], v[148:151]
    ds_read_b64_tr_b16 a[188:189], v17 offset:9280
    v_mfma_f32_16x16x32_bf16 v[148:151], a[172:175], a[4:7], v[148:151]
    v_mfma_f32_16x16x32_bf16 v[152:155], a[172:175], a[8:11], v[152:155]
    ds_read_b64_tr_b16 a[190:191], v17 offset:11584
    v_mfma_f32_16x16x32_bf16 v[152:155], a[176:179], a[12:15], v[152:155]
    v_mfma_f32_16x16x32_bf16 v[152:155], a[180:183], a[16:19], v[152:155]
    ds_read_b64_tr_b16 a[192:193], v17 offset:18496
    v_mfma_f32_16x16x32_bf16 v[156:159], a[180:183], a[20:23], v[156:159]
    v_mfma_f32_16x16x32_bf16 v[156:159], a[176:179], a[16:19], v[156:159]
    ds_read_b64_tr_b16 a[194:195], v17 offset:20800
    v_mfma_f32_16x16x32_bf16 v[156:159], a[172:175], a[12:15], v[156:159]
    v_mfma_f32_16x16x32_bf16 v[160:163], a[172:175], a[16:19], v[160:163]
    ds_read_b128 a[56:59], v19 offset:3072
    v_mfma_f32_16x16x32_bf16 v[160:163], a[176:179], a[20:23], v[160:163]
    v_mfma_f32_16x16x32_bf16 v[160:163], a[180:183], a[24:27], v[160:163]
    ds_read_b128 a[60:63], v19 offset:4096
    v_mfma_f32_16x16x32_bf16 v[164:167], a[180:183], a[28:31], v[164:167]
    v_mfma_f32_16x16x32_bf16 v[164:167], a[176:179], a[24:27], v[164:167]
    ds_read_b128 a[64:67], v19 offset:5120
    v_mfma_f32_16x16x32_bf16 v[164:167], a[172:175], a[20:23], v[164:167]
    v_mfma_f32_16x16x32_bf16 v[168:171], a[172:175], a[24:27], v[168:171]
    v_mfma_f32_16x16x32_bf16 v[168:171], a[176:179], a[28:31], v[168:171]
    v_mfma_f32_16x16x32_bf16 v[168:171], a[180:183], a[32:35], v[168:171]
    v_mfma_f32_16x16x32_bf16 v[172:175], a[180:183], a[36:39], v[172:175]
    v_mfma_f32_16x16x32_bf16 v[172:175], a[176:179], a[32:35], v[172:175]
    v_mfma_f32_16x16x32_bf16 v[172:175], a[172:175], a[28:31], v[172:175]
    s_waitcnt lgkmcnt(0)
    v_mfma_f32_16x16x32_bf16 v[176:179], a[188:191], a[4:7], v[176:179]
    ds_read_b64_tr_b16 a[196:197], v17 offset:96
    v_mfma_f32_16x16x32_bf16 v[176:179], a[192:195], a[8:11], v[176:179]
    ds_read_b64_tr_b16 a[198:199], v17 offset:2400
    v_mfma_f32_16x16x32_bf16 v[180:183], a[192:195], a[12:15], v[180:183]
    ds_read_b64_tr_b16 a[200:201], v17 offset:9312
    v_mfma_f32_16x16x32_bf16 v[180:183], a[188:191], a[8:11], v[180:183]
    ds_read_b64_tr_b16 a[202:203], v17 offset:11616
    v_mfma_f32_16x16x32_bf16 v[180:183], a[184:187], a[4:7], v[180:183]
    ds_read_b64_tr_b16 a[204:205], v17 offset:18528
    v_mfma_f32_16x16x32_bf16 v[184:187], a[184:187], a[8:11], v[184:187]
    ds_read_b64_tr_b16 a[206:207], v17 offset:20832
    v_mfma_f32_16x16x32_bf16 v[184:187], a[188:191], a[12:15], v[184:187]
    ds_read_b64_tr_b16 a[208:209], v21 offset:0
    v_mfma_f32_16x16x32_bf16 v[184:187], a[192:195], a[16:19], v[184:187]
    ds_read_b64_tr_b16 a[210:211], v21 offset:2304
    v_mfma_f32_16x16x32_bf16 v[188:191], a[192:195], a[20:23], v[188:191]
    ds_read_b64_tr_b16 a[212:213], v21 offset:9216
    v_mfma_f32_16x16x32_bf16 v[188:191], a[188:191], a[16:19], v[188:191]
    ds_read_b64_tr_b16 a[214:215], v21 offset:11520
    v_mfma_f32_16x16x32_bf16 v[188:191], a[184:187], a[12:15], v[188:191]
    ds_read_b64_tr_b16 a[216:217], v21 offset:18432
    v_mfma_f32_16x16x32_bf16 v[192:195], a[184:187], a[16:19], v[192:195]
    ds_read_b64_tr_b16 a[218:219], v21 offset:20736
    v_mfma_f32_16x16x32_bf16 v[192:195], a[188:191], a[20:23], v[192:195]
    ds_read_b128 a[68:71], v19 offset:6144
    v_mfma_f32_16x16x32_bf16 v[192:195], a[192:195], a[24:27], v[192:195]
    ds_read_b128 a[72:75], v19 offset:7168
    v_mfma_f32_16x16x32_bf16 v[196:199], a[192:195], a[28:31], v[196:199]
    ds_read_b128 a[76:79], v19 offset:8192
    v_mfma_f32_16x16x32_bf16 v[196:199], a[188:191], a[24:27], v[196:199]
    v_mfma_f32_16x16x32_bf16 v[196:199], a[184:187], a[20:23], v[196:199]
    s_mov_b32 s45, s42
    s_add_u32 s42, s42, 27648
    v_mfma_f32_16x16x32_bf16 v[200:203], a[184:187], a[24:27], v[200:203]
    s_cmp_eq_u32 s42, 148480
    s_cselect_b32 s42, 65536, s42
    v_mfma_f32_16x16x32_bf16 v[200:203], a[188:191], a[28:31], v[200:203]
    s_add_u32 s40, s40, 36864
    v_add_u32 v17, s42, v16
    v_mfma_f32_16x16x32_bf16 v[200:203], a[192:195], a[32:35], v[200:203]
    v_add_u32 v21, s42, v20
    v_mfma_f32_16x16x32_bf16 v[204:207], a[192:195], a[36:39], v[204:207]
    s_add_u32 s41, s41, 128
    v_xor_b32 v18, 32768, v18
    v_mfma_f32_16x16x32_bf16 v[204:207], a[188:191], a[32:35], v[204:207]
    s_xor_b32 s43, s43, 32768
    v_xor_b32 v19, 32768, v19
    v_mfma_f32_16x16x32_bf16 v[204:207], a[184:187], a[28:31], v[204:207]
    s_waitcnt vmcnt(16) lgkmcnt(0)
L_mid1:
    s_barrier
    v_mfma_f32_16x16x32_bf16 v[208:211], a[200:203], a[4:7], v[208:211]
    ds_read_b64_tr_b16 a[160:161], v17 offset:0
    v_mfma_f32_16x16x32_bf16 v[208:211], a[204:207], a[8:11], v[208:211]
    s_add_u32 m0, s45, 7168
    v_mfma_f32_16x16x32_bf16 v[212:215], a[204:207], a[12:15], v[212:215]
    buffer_load_dwordx4 v1, s[24:27], s40 offen offset:0 lds
    v_mfma_f32_16x16x32_bf16 v[212:215], a[200:203], a[8:11], v[212:215]
    v_mfma_f32_16x16x32_bf16 v[212:215], a[196:199], a[4:7], v[212:215]
    ds_read_b64_tr_b16 a[162:163], v17 offset:2304
    v_mfma_f32_16x16x32_bf16 v[216:219], a[196:199], a[8:11], v[216:219]
    v_mfma_f32_16x16x32_bf16 v[216:219], a[200:203], a[12:15], v[216:219]
    buffer_load_dwordx4 v2, s[24:27], s40 offen offset:1024 lds
    v_mfma_f32_16x16x32_bf16 v[216:219], a[204:207], a[16:19], v[216:219]
    v_mfma_f32_16x16x32_bf16 v[220:223], a[204:207], a[20:23], v[220:223]
    ds_read_b64_tr_b16 a[164:165], v17 offset:9216
    v_mfma_f32_16x16x32_bf16 v[220:223], a[200:203], a[16:19], v[220:223]
    v_mfma_f32_16x16x32_bf16 v[220:223], a[196:199], a[12:15], v[220:223]
    buffer_load_dwordx4 v3, s[24:27], s40 offen offset:2048 lds
    v_mfma_f32_16x16x32_bf16 v[224:227], a[196:199], a[16:19], v[224:227]
    v_mfma_f32_16x16x32_bf16 v[224:227], a[200:203], a[20:23], v[224:227]
    ds_read_b64_tr_b16 a[166:167], v17 offset:11520
    v_mfma_f32_16x16x32_bf16 v[224:227], a[204:207], a[24:27], v[224:227]
    v_mfma_f32_16x16x32_bf16 v[228:231], a[204:207], a[28:31], v[228:231]
    buffer_load_dwordx4 v4, s[24:27], s40 offen offset:3072 lds
    v_mfma_f32_16x16x32_bf16 v[228:231], a[200:203], a[24:27], v[228:231]
    v_mfma_f32_16x16x32_bf16 v[228:231], a[196:199], a[20:23], v[228:231]
    ds_read_b64_tr_b16 a[168:169], v17 offset:18432
    v_mfma_f32_16x16x32_bf16 v[232:235], a[196:199], a[24:27], v[232:235]
    s_add_u32 m0, s45, 11264
    v_mfma_f32_16x16x32_bf16 v[232:235], a[200:203], a[28:31], v[232:235]
    buffer_load_dwordx4 v5, s[24:27], s40 offen offset:0 lds
    v_mfma_f32_16x16x32_bf16 v[232:235], a[204:207], a[32:35], v[232:235]
    v_mfma_f32_16x16x32_bf16 v[236:239], a[204:207], a[36:39], v[236:239]
    ds_read_b64_tr_b16 a[170:171], v17 offset:20736
    v_mfma_f32_16x16x32_bf16 v[236:239], a[200:203], a[32:35], v[236:239]
    v_mfma_f32_16x16x32_bf16 v[236:239], a[196:199], a[28:31], v[236:239]
    buffer_load_dwordx4 v6, s[24:27], s40 offen offset:1024 lds
    v_mfma_f32_16x16x32_bf16 v[240:243], a[208:211], a[16:19], v[240:243]
    v_mfma_f32_16x16x32_bf16 v[240:243], a[212:215], a[20:23], v[240:243]
    v_mfma_f32_16x16x32_bf16 v[240:243], a[216:219], a[24:27], v[240:243]
    v_mfma_f32_16x16x32_bf16 v[244:247], a[216:219], a[28:31], v[244:247]
    buffer_load_dwordx4 v7, s[24:27], s40 offen offset:2048 lds
    v_mfma_f32_16x16x32_bf16 v[244:247], a[212:215], a[24:27], v[244:247]
    v_mfma_f32_16x16x32_bf16 v[244:247], a[208:211], a[20:23], v[244:247]
    v_mfma_f32_16x16x32_bf16 v[248:251], a[208:211], a[24:27], v[248:251]
    v_mfma_f32_16x16x32_bf16 v[248:251], a[212:215], a[28:31], v[248:251]
    v_mfma_f32_16x16x32_bf16 v[248:251], a[216:219], a[32:35], v[248:251]
    v_mfma_f32_16x16x32_bf16 v[252:255], a[216:219], a[36:39], v[252:255]
    v_mfma_f32_16x16x32_bf16 v[252:255], a[212:215], a[32:35], v[252:255]
    v_mfma_f32_16x16x32_bf16 v[252:255], a[208:211], a[28:31], v[252:255]
    s_waitcnt lgkmcnt(0)
    v_mfma_f32_16x16x32_bf16 v[112:115], a[164:167], a[44:47], v[112:115]
    ds_read_b64_tr_b16 a[172:173], v17 offset:32
    v_mfma_f32_16x16x32_bf16 v[112:115], a[168:171], a[48:51], v[112:115]
    v_mfma_f32_16x16x32_bf16 v[116:119], a[168:171], a[52:55], v[116:119]
    s_add_u32 m0, s43, 4096
    ds_read_b64_tr_b16 a[174:175], v17 offset:2336
    v_mfma_f32_16x16x32_bf16 v[116:119], a[164:167], a[48:51], v[116:119]
    buffer_load_dwordx4 v8, s[20:23], s41 offen offset:0 lds
    v_mfma_f32_16x16x32_bf16 v[116:119], a[160:163], a[44:47], v[116:119]
    v_mfma_f32_16x16x32_bf16 v[120:123], a[160:163], a[48:51], v[120:123]
    ds_read_b64_tr_b16 a[176:177], v17 offset:9248
    v_mfma_f32_16x16x32_bf16 v[120:123], a[164:167], a[52:55], v[120:123]
    v_mfma_f32_16x16x32_bf16 v[120:123], a[168:171], a[56:59], v[120:123]
    v_mfma_f32_16x16x32_bf16 v[124:127], a[168:171], a[60:63], v[124:127]
    ds_read_b64_tr_b16 a[178:179], v17 offset:11552
    v_mfma_f32_16x16x32_bf16 v[124:127], a[164:167], a[56:59], v[124:127]
    buffer_load_dwordx4 v9, s[20:23], s41 offen offset:1024 lds
    v_mfma_f32_16x16x32_bf16 v[124:127], a[160:163], a[52:55], v[124:127]
    v_mfma_f32_16x16x32_bf16 v[128:131], a[160:163], a[56:59], v[128:131]
    ds_read_b64_tr_b16 a[180:181], v17 offset:18464
    v_mfma_f32_16x16x32_bf16 v[128:131], a[164:167], a[60:63], v[128:131]
    v_mfma_f32_16x16x32_bf16 v[128:131], a[168:171], a[64:67], v[128:131]
    ds_read_b64_tr_b16 a[182:183], v17 offset:20768
    v_mfma_f32_16x16x32_bf16 v[132:135], a[168:171], a[68:71], v[132:135]
    v_mfma_f32_16x16x32_bf16 v[132:135], a[164:167], a[64:67], v[132:135]
    buffer_load_dwordx4 v10, s[20:23], s41 offen offset:2048 lds
    v_mfma_f32_16x16x32_bf16 v[132:135], a[160:163], a[60:63], v[132:135]
    v_mfma_f32_16x16x32_bf16 v[136:139], a[160:163], a[64:67], v[136:139]
    v_mfma_f32_16x16x32_bf16 v[136:139], a[164:167], a[68:71], v[136:139]
    v_mfma_f32_16x16x32_bf16 v[136:139], a[168:171], a[72:75], v[136:139]
    v_mfma_f32_16x16x32_bf16 v[140:143], a[168:171], a[76:79], v[140:143]
    v_mfma_f32_16x16x32_bf16 v[140:143], a[164:167], a[72:75], v[140:143]
    buffer_load_dwordx4 v11, s[20:23], s41 offen offset:3072 lds
    v_mfma_f32_16x16x32_bf16 v[140:143], a[160:163], a[68:71], v[140:143]
    s_waitcnt lgkmcnt(0)
    v_mfma_f32_16x16x32_bf16 v[144:147], a[176:179], a[44:47], v[144:147]
    ds_read_b64_tr_b16 a[184:185], v17 offset:64
    v_mfma_f32_16x16x32_bf16 v[144:147], a[180:183], a[48:51], v[144:147]
    v_mfma_f32_16x16x32_bf16 v[148:151], a[180:183], a[52:55], v[148:151]
    ds_read_b64_tr_b16 a[186:187], v17 offset:2368
    v_mfma_f32_16x16x32_bf16 v[148:151], a[176:179], a[48:51], v[148:151]
    s_add_u32 m0, s43, 20480
    v_mfma_f32_16x16x32_bf16 v[148:151], a[172:175], a[44:47], v[148:151]
    buffer_load_dwordx4 v12, s[20:23], s41 offen offset:0 lds
    v_mfma_f32_16x16x32_bf16 v[152:155], a[172:175], a[48:51], v[152:155]
    ds_read_b64_tr_b16 a[188:189], v17 offset:9280
    v_mfma_f32_16x16x32_bf16 v[152:155], a[176:179], a[52:55], v[152:155]
    v_mfma_f32_16x16x32_bf16 v[152:155], a[180:183], a[56:59], v[152:155]
    v_mfma_f32_16x16x32_bf16 v[156:159], a[180:183], a[60:63], v[156:159]
    ds_read_b64_tr_b16 a[190:191], v17 offset:11584
    v_mfma_f32_16x16x32_bf16 v[156:159], a[176:179], a[56:59], v[156:159]
    v_mfma_f32_16x16x32_bf16 v[156:159], a[172:175], a[52:55], v[156:159]
    buffer_load_dwordx4 v13, s[20:23], s41 offen offset:1024 lds
    v_mfma_f32_16x16x32_bf16 v[160:163], a[172:175], a[56:59], v[160:163]
    ds_read_b64_tr_b16 a[192:193], v17 offset:18496
    v_mfma_f32_16x16x32_bf16 v[160:163], a[176:179], a[60:63], v[160:163]
    v_mfma_f32_16x16x32_bf16 v[160:163], a[180:183], a[64:67], v[160:163]
    ds_read_b64_tr_b16 a[194:195], v17 offset:20800
    v_mfma_f32_16x16x32_bf16 v[164:167], a[180:183], a[68:71], v[164:167]
    v_mfma_f32_16x16x32_bf16 v[164:167], a[176:179], a[64:67], v[164:167]
    v_mfma_f32_16x16x32_bf16 v[164:167], a[172:175], a[60:63], v[164:167]
    buffer_load_dwordx4 v14, s[20:23], s41 offen offset:2048 lds
    v_mfma_f32_16x16x32_bf16 v[168:171], a[172:175], a[64:67], v[168:171]
    v_mfma_f32_16x16x32_bf16 v[168:171], a[176:179], a[68:71], v[168:171]
    v_mfma_f32_16x16x32_bf16 v[168:171], a[180:183], a[72:75], v[168:171]
    v_mfma_f32_16x16x32_bf16 v[172:175], a[180:183], a[76:79], v[172:175]
    v_mfma_f32_16x16x32_bf16 v[172:175], a[176:179], a[72:75], v[172:175]
    v_mfma_f32_16x16x32_bf16 v[172:175], a[172:175], a[68:71], v[172:175]
    buffer_load_dwordx4 v15, s[20:23], s41 offen offset:3072 lds
    s_waitcnt lgkmcnt(0)
    v_mfma_f32_16x16x32_bf16 v[176:179], a[188:191], a[44:47], v[176:179]
    ds_read_b64_tr_b16 a[196:197], v17 offset:96
    v_mfma_f32_16x16x32_bf16 v[176:179], a[192:195], a[48:51], v[176:179]
    ds_read_b64_tr_b16 a[198:199], v17 offset:2400
    v_mfma_f32_16x16x32_bf16 v[180:183], a[192:195], a[52:55], v[180:183]
    ds_read_b64_tr_b16 a[200:201], v17 offset:9312
    v_mfma_f32_16x16x32_bf16 v[180:183], a[188:191], a[48:51], v[180:183]
    v_mfma_f32_16x16x32_bf16 v[180:183], a[184:187], a[44:47], v[180:183]
    ds_read_b64_tr_b16 a[202:203], v17 offset:11616
    v_mfma_f32_16x16x32_bf16 v[184:187], a[184:187], a[48:51], v[184:187]
    ds_read_b64_tr_b16 a[204:205], v17 offset:18528
    v_mfma_f32_16x16x32_bf16 v[184:187], a[188:191], a[52:55], v[184:187]
    ds_read_b64_tr_b16 a[206:207], v17 offset:20832
    v_mfma_f32_16x16x32_bf16 v[184:187], a[192:195], a[56:59], v[184:187]
    v_mfma_f32_16x16x32_bf16 v[188:191], a[192:195], a[60:63], v[188:191]
    ds_read_b64_tr_b16 a[208:209], v21 offset:0
    v_mfma_f32_16x16x32_bf16 v[188:191], a[188:191], a[56:59], v[188:191]
    ds_read_b64_tr_b16 a[210:211], v21 offset:2304
    v_mfma_f32_16x16x32_bf16 v[188:191], a[184:187], a[52:55], v[188:191]
    ds_read_b64_tr_b16 a[212:213], v21 offset:9216
    v_mfma_f32_16x16x32_bf16 v[192:195], a[184:187], a[56:59], v[192:195]
    v_mfma_f32_16x16x32_bf16 v[192:195], a[188:191], a[60:63], v[192:195]
    ds_read_b64_tr_b16 a[214:215], v21 offset:11520
    v_mfma_f32_16x16x32_bf16 v[192:195], a[192:195], a[64:67], v[192:195]
    ds_read_b64_tr_b16 a[216:217], v21 offset:18432
    v_mfma_f32_16x16x32_bf16 v[196:199], a[192:195], a[68:71], v[196:199]
    ds_read_b64_tr_b16 a[218:219], v21 offset:20736
    v_mfma_f32_16x16x32_bf16 v[196:199], a[188:191], a[64:67], v[196:199]
    v_mfma_f32_16x16x32_bf16 v[196:199], a[184:187], a[60:63], v[196:199]
    s_mov_b32 s45, s42
    s_add_u32 s42, s42, 27648
    v_mfma_f32_16x16x32_bf16 v[200:203], a[184:187], a[64:67], v[200:203]
    s_cmp_eq_u32 s42, 148480
    s_cselect_b32 s42, 65536, s42
    v_mfma_f32_16x16x32_bf16 v[200:203], a[188:191], a[68:71], v[200:203]
    s_add_u32 s40, s40, 36864
    v_add_u32 v17, s42, v16
    v_mfma_f32_16x16x32_bf16 v[200:203], a[192:195], a[72:75], v[200:203]
    v_add_u32 v21, s42, v20
    v_mfma_f32_16x16x32_bf16 v[204:207], a[192:195], a[76:79], v[204:207]
    v_mfma_f32_16x16x32_bf16 v[204:207], a[188:191], a[72:75], v[204:207]
    v_mfma_f32_16x16x32_bf16 v[204:207], a[184:187], a[68:71], v[204:207]
    s_waitcnt vmcnt(16) lgkmcnt(0)
    s_barrier
    v_mfma_f32_16x16x32_bf16 v[208:211], a[200:203], a[44:47], v[208:211]
    ds_read_b64_tr_b16 a[160:161], v17 offset:0
    v_mfma_f32_16x16x32_bf16 v[208:211], a[204:207], a[48:51], v[208:211]
    s_add_u32 m0, s45, 7168
    ds_read_b64_tr_b16 a[162:163], v17 offset:2304
    v_mfma_f32_16x16x32_bf16 v[212:215], a[204:207], a[52:55], v[212:215]
    buffer_load_dwordx4 v1, s[24:27], s40 offen offset:0 lds
    v_mfma_f32_16x16x32_bf16 v[212:215], a[200:203], a[48:51], v[212:215]
    ds_read_b64_tr_b16 a[164:165], v17 offset:9216
    v_mfma_f32_16x16x32_bf16 v[212:215], a[196:199], a[44:47], v[212:215]
    ds_read_b64_tr_b16 a[166:167], v17 offset:11520
    v_mfma_f32_16x16x32_bf16 v[216:219], a[196:199], a[48:51], v[216:219]
    ds_read_b64_tr_b16 a[168:169], v17 offset:18432
    v_mfma_f32_16x16x32_bf16 v[216:219], a[200:203], a[52:55], v[216:219]
    buffer_load_dwordx4 v2, s[24:27], s40 offen offset:1024 lds
    v_mfma_f32_16x16x32_bf16 v[216:219], a[204:207], a[56:59], v[216:219]
    v_mfma_f32_16x16x32_bf16 v[220:223], a[204:207], a[60:63], v[220:223]
    ds_read_b64_tr_b16 a[170:171], v17 offset:20736
    v_mfma_f32_16x16x32_bf16 v[220:223], a[200:203], a[56:59], v[220:223]
    ds_read_b128 a[4:7], v18 offset:0
    v_mfma_f32_16x16x32_bf16 v[220:223], a[196:199], a[52:55], v[220:223]
    buffer_load_dwordx4 v3, s[24:27], s40 offen offset:2048 lds
    v_mfma_f32_16x16x32_bf16 v[224:227], a[196:199], a[56:59], v[224:227]
    ds_read_b128 a[8:11], v18 offset:1024
    v_mfma_f32_16x16x32_bf16 v[224:227], a[200:203], a[60:63], v[224:227]
    ds_read_b128 a[12:15], v18 offset:2048
    v_mfma_f32_16x16x32_bf16 v[224:227], a[204:207], a[64:67], v[224:227]
    ds_read_b128 a[16:19], v18 offset:3072
    v_mfma_f32_16x16x32_bf16 v[228:231], a[204:207], a[68:71], v[228:231]
    buffer_load_dwordx4 v4, s[24:27], s40 offen offset:3072 lds
    v_mfma_f32_16x16x32_bf16 v[228:231], a[200:203], a[64:67], v[228:231]
    v_mfma_f32_16x16x32_bf16 v[228:231], a[196:199], a[60:63], v[228:231]
    ds_read_b128 a[20:23], v18 offset:4096
    v_mfma_f32_16x16x32_bf16 v[232:235], a[196:199], a[64:67], v[232:235]
    s_add_u32 m0, s45, 11264
    ds_read_b128 a[24:27], v18 offset:5120
    v_mfma_f32_16x16x32_bf16 v[232:235], a[200:203], a[68:71], v[232:235]
    buffer_load_dwordx4 v5, s[24:27], s40 offen offset:0 lds
    v_mfma_f32_16x16x32_bf16 v[232:235], a[204:207], a[72:75], v[232:235]
    ds_read_b128 a[28:31], v18 offset:6144
    v_mfma_f32_16x16x32_bf16 v[236:239], a[204:207], a[76:79], v[236:239]
    ds_read_b128 a[32:35], v18 offset:7168
    v_mfma_f32_16x16x32_bf16 v[236:239], a[200:203], a[72:75], v[236:239]
    ds_read_b128 a[36:39], v18 offset:8192
    v_mfma_f32_16x16x32_bf16 v[236:239], a[196:199], a[68:71], v[236:239]
    buffer_load_dwordx4 v6, s[24:27], s40 offen offset:1024 lds
    v_mfma_f32_16x16x32_bf16 v[240:243], a[208:211], a[56:59], v[240:243]
    v_mfma_f32_16x16x32_bf16 v[240:243], a[212:215], a[60:63], v[240:243]
    v_mfma_f32_16x16x32_bf16 v[240:243], a[216:219], a[64:67], v[240:243]
    v_mfma_f32_16x16x32_bf16 v[244:247], a[216:219], a[68:71], v[244:247]
    buffer_load_dwordx4 v7, s[24:27], s40 offen offset:2048 lds
    v_mfma_f32_16x16x32_bf16 v[244:247], a[212:215], a[64:67], v[244:247]
    v_mfma_f32_16x16x32_bf16 v[244:247], a[208:211], a[60:63], v[244:247]
    v_mfma_f32_16x16x32_bf16 v[248:251], a[208:211], a[64:67], v[248:251]
    v_mfma_f32_16x16x32_bf16 v[248:251], a[212:215], a[68:71], v[248:251]
    v_mfma_f32_16x16x32_bf16 v[248:251], a[216:219], a[72:75], v[248:251]
    v_mfma_f32_16x16x32_bf16 v[252:255], a[216:219], a[76:79], v[252:255]
    v_mfma_f32_16x16x32_bf16 v[252:255], a[212:215], a[72:75], v[252:255]
    s_add_u32 s44, s44, 1
    s_cmp_eq_u32 s44, 7
    v_mfma_f32_16x16x32_bf16 v[252:255], a[208:211], a[68:71], v[252:255]
    s_cbranch_scc0 L_loop1
    s_branch L_tail
.if (. - L_w1) > 4096
.error "variant page overflow"
.endif
.p2align 12
L_w2:
    s_cbranch_vccnz L_backA
    s_waitcnt vmcnt(11)
    s_barrier
    ds_read_b64_tr_b16 a[168:169], v17 offset:18432
    ds_read_b64_tr_b16 a[170:171], v17 offset:20736
    ds_read_b128 a[8:11], v18 offset:9216
    ds_read_b64_tr_b16 a[164:165], v17 offset:9216
    ds_read_b64_tr_b16 a[166:167], v17 offset:11520
    ds_read_b128 a[4:7], v18 offset:8192
    ds_read_b64_tr_b16 a[160:161], v17 offset:0
    ds_read_b64_tr_b16 a[162:163], v17 offset:2304
    ds_read_b128 a[0:3], v18 offset:7168
    ds_read_b128 a[12:15], v18 offset:10240
    ds_read_b128 a[16:19], v18 offset:11264
    ds_read_b128 a[20:23], v18 offset:12288
    ds_read_b128 a[24:27], v18 offset:13312
    ds_read_b128 a[28:31], v18 offset:14336
    ds_read_b128 a[32:35], v18 offset:15360
    s_waitcnt lgkmcnt(12)
    v_mfma_f32_16x16x32_bf16 v[112:115], a[168:171], a[8:11], 0
    s_waitcnt lgkmcnt(9)
    v_mfma_f32_16x16x32_bf16 v[112:115], a[164:167], a[4:7], v[112:115]
    s_add_u32 m0, s43, 8192
    s_waitcnt lgkmcnt(6)
    v_mfma_f32_16x16x32_bf16 v[112:115], a[160:163], a[0:3], v[112:115]
    buffer_load_dwordx4 v8, s[20:23], s41 offen offset:0 lds
    v_mfma_f32_16x16x32_bf16 v[116:119], a[160:163], a[4:7], 0
    ds_read_b64_tr_b16 a[172:173], v17 offset:32
    v_mfma_f32_16x16x32_bf16 v[116:119], a[164:167], a[8:11], v[116:119]
    ds_read_b64_tr_b16 a[174:175], v17 offset:2336
    s_waitcnt lgkmcnt(6)
    v_mfma_f32_16x16x32_bf16 v[116:119], a[168:171], a[12:15], v[116:119]
    buffer_load_dwordx4 v9, s[20:23], s41 offen offset:1024 lds
    v_mfma_f32_16x16x32_bf16 v[120:123], a[168:171], a[16:19], 0
    ds_read_b64_tr_b16 a[176:177], v17 offset:9248
    v_mfma_f32_16x16x32_bf16 v[120:123], a[164:167], a[12:15], v[120:123]
    v_mfma_f32_16x16x32_bf16 v[120:123], a[160:163], a[8:11], v[120:123]
    ds_read_b64_tr_b16 a[178:179], v17 offset:11552
    v_mfma_f32_16x16x32_bf16 v[124:127], a[160:163], a[12:15], 0
    buffer_load_dwordx4 v10, s[20:23], s41 offen offset:2048 lds
    ds_read_b64_tr_b16 a[180:181], v17 offset:18464
    v_mfma_f32_16x16x32_bf16 v[124:127], a[164:167], a[16:19], v[124:127]
    ds_read_b64_tr_b16 a[182:183], v17 offset:20768
    s_waitcnt lgkmcnt(6)
    v_mfma_f32_16x16x32_bf16 v[124:127], a[168:171], a[20:23], v[124:127]
    v_mfma_f32_16x16x32_bf16 v[128:131], a[168:171], a[24:27], 0
    ds_read_b128 a[40:43], v19 offset:7168
    v_mfma_f32_16x16x32_bf16 v[128:131], a[164:167], a[20:23], v[128:131]
    buffer_load_dwordx4 v11, s[20:23], s41 offen offset:3072 lds
    v_mfma_f32_16x16x32_bf16 v[128:131], a[160:163], a[16:19], v[128:131]
    ds_read_b128 a[44:47], v19 offset:8192
    v_mfma_f32_16x16x32_bf16 v[132:135], a[160:163], a[20:23], 0
    ds_read_b128 a[48:51], v19 offset:9216
    v_mfma_f32_16x16x32_bf16 v[132:135], a[164:167], a[24:27], v[132:135]
    s_add_u32 m0, s43, 24576
    v_mfma_f32_16x16x32_bf16 v[132:135], a[168:171], a[28:31], v[132:135]
    buffer_load_dwordx4 v12, s[20:23], s41 offen offset:0 lds
    v_mfma_f32_16x16x32_bf16 v[136:139], a[168:171], a[32:35], 0
    v_mfma_f32_16x16x32_bf16 v[136:139], a[164:167], a[28:31], v[136:139]
    v_mfma_f32_16x16x32_bf16 v[136:139], a[160:163], a[24:27], v[136:139]
    v_mfma_f32_16x16x32_bf16 v[140:143], a[160:163], a[28:31], 0
    buffer_load_dwordx4 v13, s[20:23], s41 offen offset:1024 lds
    v_mfma_f32_16x16x32_bf16 v[140:143], a[164:167], a[32:35], v[140:143]
    s_waitcnt lgkmcnt(0)
    v_mfma_f32_16x16x32_bf16 v[144:147], a[180:183], a[8:11], 0
    ds_read_b64_tr_b16 a[184:185], v17 offset:64
    v_mfma_f32_16x16x32_bf16 v[144:147], a[176:179], a[4:7], v[144:147]
    ds_read_b64_tr_b16 a[186:187], v17 offset:2368
    v_mfma_f32_16x16x32_bf16 v[144:147], a[172:175], a[0:3], v[144:147]
    buffer_load_dwordx4 v14, s[20:23], s41 offen offset:2048 lds
    v_mfma_f32_16x16x32_bf16 v[148:151], a[172:175], a[4:7], 0
    ds_read_b64_tr_b16 a[188:189], v17 offset:9280
    v_mfma_f32_16x16x32_bf16 v[148:151], a[176:179], a[8:11], v[148:151]
    v_mfma_f32_16x16x32_bf16 v[148:151], a[180:183], a[12:15], v[148:151]
    ds_read_b64_tr_b16 a[190:191], v17 offset:11584
    v_mfma_f32_16x16x32_bf16 v[152:155], a[180:183], a[16:19], 0
    buffer_load_dwordx4 v15, s[20:23], s41 offen offset:3072 lds
    v_mfma_f32_16x16x32_bf16 v[152:155], a[176:179], a[12:15], v[152:155]
    ds_read_b64_tr_b16 a[192:193], v17 offset:18496
    v_mfma_f32_16x16x32_bf16 v[152:155], a[172:175], a[8:11], v[152:155]
    s_add_u32 m0, s45, 14336
    v_mfma_f32_16x16x32_bf16 v[156:159], a[172:175], a[12:15], 0
    buffer_load_dwordx4 v1, s[24:27], s40 offen offset:0 lds
    v_mfma_f32_16x16x32_bf16 v[156:159], a[176:179], a[16:19], v[156:159]
    ds_read_b64_tr_b16 a[194:195], v17 offset:20800
    v_mfma_f32_16x16x32_bf16 v[156:159], a[180:183], a[20:23], v[156:159]
    ds_read_b128 a[52:55], v19 offset:10240
    v_mfma_f32_16x16x32_bf16 v[160:163], a[180:183], a[24:27], 0
    v_mfma_f32_16x16x32_bf16 v[160:163], a[176:179], a[20:23], v[160:163]
    buffer_load_dwordx4 v2, s[24:27], s40 offen offset:1024 lds
    v_mfma_f32_16x16x32_bf16 v[160:163], a[172:175], a[16:19], v[160:163]
    ds_read_b128 a[56:59], v19 offset:11264
    v_mfma_f32_16x16x32_bf16 v[164:167], a[172:175], a[20:23], 0
    ds_read_b128 a[60:63], v19 offset:12288
    v_mfma_f32_16x16x32_bf16 v[164:167], a[176:179], a[24:27], v[164:167]
    v_mfma_f32_16x16x32_bf16 v[164:167], a[180:183], a[28:31], v[164:167]
    buffer_load_dwordx4 v3, s[24:27], s40 offen offset:2048 lds
    v_mfma_f32_16x16x32_bf16 v[168:171], a[180:183], a[32:35], 0
    v_mfma_f32_16x16x32_bf16 v[168:171], a[176:179], a[28:31], v[168:171]
    v_mfma_f32_16x16x32_bf16 v[168:171], a[172:175], a[24:27], v[168:171]
    v_mfma_f32_16x16x32_bf16 v[172:175], a[172:175], a[28:31], 0
    buffer_load_dwordx4 v4, s[24:27], s40 offen offset:3072 lds
    v_mfma_f32_16x16x32_bf16 v[172:175], a[176:179], a[32:35], v[172:175]
    s_waitcnt lgkmcnt(0)
    v_mfma_f32_16x16x32_bf16 v[176:179], a[192:195], a[8:11], 0
    ds_read_b64_tr_b16 a[196:197], v17 offset:96
    v_mfma_f32_16x16x32_bf16 v[176:179], a[188:191], a[4:7], v[176:179]
    s_add_u32 m0, s45, 18432
    ds_read_b64_tr_b16 a[198:199], v17 offset:2400
    v_mfma_f32_16x16x32_bf16 v[176:179], a[184:187], a[0:3], v[176:179]
    buffer_load_dwordx4 v5, s[24:27], s40 offen offset:0 lds
    ds_read_b64_tr_b16 a[200:201], v17 offset:9312
    v_mfma_f32_16x16x32_bf16 v[180:183], a[184:187], a[4:7], 0
    ds_read_b64_tr_b16 a[202:203], v17 offset:11616
    v_mfma_f32_16x16x32_bf16 v[180:183], a[188:191], a[8:11], v[180:183]
    ds_read_b64_tr_b16 a[204:205], v17 offset:18528
    v_mfma_f32_16x16x32_bf16 v[180:183], a[192:195], a[12:15], v[180:183]
    ds_read_b64_tr_b16 a[206:207], v17 offset:20832
    v_mfma_f32_16x16x32_bf16 v[184:187], a[192:195], a[16:19], 0
    buffer_load_dwordx4 v6, s[24:27], s40 offen offset:1024 lds
    ds_read_b64_tr_b16 a[208:209], v21 offset:0
    v_mfma_f32_16x16x32_bf16 v[184:187], a[188:191], a[12:15], v[184:187]
    ds_read_b64_tr_b16 a[210:211], v21 offset:2304
    v_mfma_f32_16x16x32_bf16 v[184:187], a[184:187], a[8:11], v[184:187]
    ds_read_b64_tr_b16 a[212:213], v21 offset:9216
    v_mfma_f32_16x16x32_bf16 v[188:191], a[184:187], a[12:15], 0
    ds_read_b64_tr_b16 a[214:215], v21 offset:11520
    v_mfma_f32_16x16x32_bf16 v[188:191], a[188:191], a[16:19], v[188:191]
    buffer_load_dwordx4 v7, s[24:27], s40 offen offset:2048 lds
    ds_read_b64_tr_b16 a[216:217], v21 offset:18432
    v_mfma_f32_16x16x32_bf16 v[188:191], a[192:195], a[20:23], v[188:191]
    ds_read_b64_tr_b16 a[218:219], v21 offset:20736
    v_mfma_f32_16x16x32_bf16 v[192:195], a[192:195], a[24:27], 0
    ds_read_b128 a[64:67], v19 offset:13312
    v_mfma_f32_16x16x32_bf16 v[192:195], a[188:191], a[20:23], v[192:195]
    ds_read_b128 a[68:71], v19 offset:14336
    v_mfma_f32_16x16x32_bf16 v[192:195], a[184:187], a[16:19], v[192:195]
    ds_read_b128 a[72:75], v19 offset:15360
    v_mfma_f32_16x16x32_bf16 v[196:199], a[184:187], a[20:23], 0
    v_mfma_f32_16x16x32_bf16 v[196:199], a[188:191], a[24:27], v[196:199]
    global_load_dword v23, v52, s[58:59]
    s_mov_b32 s45, s42
    s_add_u32 s42, s42, 27648
    v_mfma_f32_16x16x32_bf16 v[196:199], a[192:195], a[28:31], v[196:199]
    s_cmp_eq_u32 s42, 148480
    s_cselect_b32 s42, 65536, s42
    v_mfma_f32_16x16x32_bf16 v[200:203], a[192:195], a[32:35], 0
    s_add_u32 s40, s40, 36864
    v_add_u32 v17, s42, v16
    v_mfma_f32_16x16x32_bf16 v[200:203], a[188:191], a[28:31], v[200:203]
    v_add_u32 v21, s42, v20
    v_mfma_f32_16x16x32_bf16 v[200:203], a[184:187], a[24:27], v[200:203]
    s_add_u32 s41, s41, 128
    v_xor_b32 v18, 32768, v18
    v_mfma_f32_16x16x32_bf16 v[204:207], a[184:187], a[28:31], 0
    s_xor_b32 s43, s43, 32768
    v_xor_b32 v19, 32768, v19
    v_mfma_f32_16x16x32_bf16 v[204:207], a[188:191], a[32:35], v[204:207]
    s_waitcnt vmcnt(20) lgkmcnt(0)
    s_branch L_mid2
L_loop2:
    s_waitcnt lgkmcnt(0)
    v_mfma_f32_16x16x32_bf16 v[112:115], a[168:171], a[8:11], v[112:115]
    ds_read_b64_tr_b16 a[172:173], v17 offset:32
    v_mfma_f32_16x16x32_bf16 v[112:115], a[164:167], a[4:7], v[112:115]
    ds_read_b64_tr_b16 a[174:175], v17 offset:2336
    v_mfma_f32_16x16x32_bf16 v[112:115], a[160:163], a[0:3], v[112:115]
    v_mfma_f32_16x16x32_bf16 v[116:119], a[160:163], a[4:7], v[116:119]
    ds_read_b64_tr_b16 a[176:177], v17 offset:9248
    v_mfma_f32_16x16x32_bf16 v[116:119], a[164:167], a[8:11], v[116:119]
    v_mfma_f32_16x16x32_bf16 v[116:119], a[168:171], a[12:15], v[116:119]
    ds_read_b64_tr_b16 a[178:179], v17 offset:11552
    v_mfma_f32_16x16x32_bf16 v[120:123], a[168:171], a[16:19], v[120:123]
    v_mfma_f32_16x16x32_bf16 v[120:123], a[164:167], a[12:15], v[120:123]
    ds_read_b64_tr_b16 a[180:181], v17 offset:18464
    v_mfma_f32_16x16x32_bf16 v[120:123], a[160:163], a[8:11], v[120:123]
    global_load_dword v23, v52, s[58:59]
    v_mfma_f32_16x16x32_bf16 v[124:127], a[160:163], a[12:15], v[124:127]
    ds_read_b64_tr_b16 a[182:183], v17 offset:20768
    v_mfma_f32_16x16x32_bf16 v[124:127], a[164:167], a[16:19], v[124:127]
    v_mfma_f32_16x16x32_bf16 v[124:127], a[168:171], a[20:23], v[124:127]
    ds_read_b128 a[40:43], v19 offset:7168
    v_mfma_f32_16x16x32_bf16 v[128:131], a[168:171], a[24:27], v[128:131]
    v_mfma_f32_16x16x32_bf16 v[128:131], a[164:167], a[20:23], v[128:131]
    ds_read_b128 a[44:47], v19 offset:8192
    v_mfma_f32_16x16x32_bf16 v[128:131], a[160:163], a[16:19], v[128:131]
    v_mfma_f32_16x16x32_bf16 v[132:135], a[160:163], a[20:23], v[132:135]
    ds_read_b128 a[48:51], v19 offset:9216
    v_mfma_f32_16x16x32_bf16 v[132:135], a[164:167], a[24:27], v[132:135]
    v_mfma_f32_16x16x32_bf16 v[132:135], a[168:171], a[28:31], v[132:135]
    v_mfma_f32_16x16x32_bf16 v[136:139], a[168:171], a[32:35], v[136:139]
    v_mfma_f32_16x16x32_bf16 v[136:139], a[164:167], a[28:31], v[136:139]
    v_mfma_f32_16x16x32_bf16 v[136:139], a[160:163], a[24:27], v[136:139]
    v_mfma_f32_16x16x32_bf16 v[140:143], a[160:163], a[28:31], v[140:143]
    v_mfma_f32_16x16x32_bf16 v[140:143], a[164:167], a[32:35], v[140:143]
    s_waitcnt lgkmcnt(0)
    v_mfma_f32_16x16x32_bf16 v[144:147], a[180:183], a[8:11], v[144:147]
    ds_read_b64_tr_b16 a[184:185], v17 offset:64
    v_mfma_f32_16x16x32_bf16 v[144:147], a[176:179], a[4:7], v[144:147]
    ds_read_b64_tr_b16 a[186:187], v17 offset:2368
    v_mfma_f32_16x16x32_bf16 v[144:147], a[172:175], a[0:3], v[144:147]
    v_mfma_f32_16x16x32_bf16 v[148:151], a[172:175], a[4:7], v[148:151]
    ds_read_b64_tr_b16 a[188:189], v17 offset:9280
    v_mfma_f32_16x16x32_bf16 v[148:151], a[176:179], a[8:11], v[148:151]
    v_mfma_f32_16x16x32_bf16 v[148:151], a[180:183], a[12:15], v[148:151]
    ds_read_b64_tr_b16 a[190:191], v17 offset:11584
    v_mfma_f32_16x16x32_bf16 v[152:155], a[180:183], a[16:19], v[152:155]
    v_mfma_f32_16x16x32_bf16 v[152:155], a[176:179], a[12:15], v[152:155]
    ds_read_b64_tr_b16 a[192:193], v17 offset:18496
    v_mfma_f32_16x16x32_bf16 v[152:155], a[172:175], a[8:11], v[152:155]
    v_mfma_f32_16x16x32_bf16 v[156:159], a[172:175], a[12:15], v[156:159]
    ds_read_b64_tr_b16 a[194:195], v17 offset:20800
    v_mfma_f32_16x16x32_bf16 v[156:159], a[176:179], a[16:19], v[156:159]
    v_mfma_f32_16x16x32_bf16 v[156:159], a[180:183], a[20:23], v[156:159]
    ds_read_b128 a[52:55], v19 offset:10240
    v_mfma_f32_16x16x32_bf16 v[160:163], a[180:183], a[24:27], v[160:163]
    v_mfma_f32_16x16x32_bf16 v[160:163], a[176:179], a[20:23], v[160:163]
    ds_read_b128 a[56:59], v19 offset:11264
    v_mfma_f32_16x16x32_bf16 v[160:163], a[172:175], a[16:19], v[160:163]
    v_mfma_f32_16x16x32_bf16 v[164:167], a[172:175], a[20:23], v[164:167]
    ds_read_b128 a[60:63], v19 offset:12288
    v_mfma_f32_16x16x32_bf16 v[164:167], a[176:179], a[24:27], v[164:167]
    v_mfma_f32_16x16x32_bf16 v[164:167], a[180:183], a[28:31], v[164:167]
    v_mfma_f32_16x16x32_bf16 v[168:171], a[180:183], a[32:35], v[168:171]
    v_mfma_f32_16x16x32_bf16 v[168:171], a[176:179], a[28:31], v[168:171]
    v_mfma_f32_16x16x32_bf16 v[168:171], a[172:175], a[24:27], v[168:171]
    v_mfma_f32_16x16x32_bf16 v[172:175], a[172:175], a[28:31], v[172:175]
    v_mfma_f32_16x16x32_bf16 v[172:175], a[176:179], a[32:35], v[172:175]
    s_waitcnt lgkmcnt(0)
    v_mfma_f32_16x16x32_bf16 v[176:179], a[192:195], a[8:11], v[176:179]
    ds_read_b64_tr_b16 a[196:197], v17 offset:96
    v_mfma_f32_16x16x32_bf16 v[176:179], a[188:191], a[4:7], v[176:179]
    ds_read_b64_tr_b16 a[198:199], v17 offset:2400
    v_mfma_f32_16x16x32_bf16 v[176:179], a[184:187], a[0:3], v[176:179]
    ds_read_b64_tr_b16 a[200:201], v17 offset:9312
    v_mfma_f32_16x16x32_bf16 v[180:183], a[184:187], a[4:7], v[180:183]
    ds_read_b64_tr_b16 a[202:203], v17 offset:11616
    v_mfma_f32_16x16x32_bf16 v[180:183], a[188:191], a[8:11], v[180:183]
    ds_read_b64_tr_b16 a[204:205], v17 offset:18528
    v_mfma_f32_16x16x32_bf16 v[180:183], a[192:195], a[12:15], v[180:183]
    ds_read_b64_tr_b16 a[206:207], v17 offset:20832
    v_mfma_f32_16x16x32_bf16 v[184:187], a[192:195], a[16:19], v[184:187]
    ds_read_b64_tr_b16 a[208:209], v21 offset:0
    v_mfma_f32_16x16x32_bf16 v[184:187], a[188:191], a[12:15], v[184:187]
    ds_read_b64_tr_b16 a[210:211], v21 offset:2304
    v_mfma_f32_16x16x32_bf16 v[184:187], a[184:187], a[8:11], v[184:187]
    ds_read_b64_tr_b16 a[212:213], v21 offset:9216
    v_mfma_f32_16x16x32_bf16 v[188:191], a[184:187], a[12:15], v[188:191]
    ds_read_b64_tr_b16 a[214:215], v21 offset:11520
    v_mfma_f32_16x16x32_bf16 v[188:191], a[188:191], a[16:19], v[188:191]
    ds_read_b64_tr_b16 a[216:217], v21 offset:18432
    v_mfma_f32_16x16x32_bf16 v[188:191], a[192:195], a[20:23], v[188:191]
    ds_read_b64_tr_b16 a[218:219], v21 offset:20736
    v_mfma_f32_16x16x32_bf16 v[192:195], a[192:195], a[24:27], v[192:195]
    ds_read_b128 a[64:67], v19 offset:13312
    v_mfma_f32_16x16x32_bf16 v[192:195], a[188:191], a[20:23], v[192:195]
    ds_read_b128 a[68:71], v19 offset:14336
    v_mfma_f32_16x16x32_bf16 v[192:195], a[184:187], a[16:19], v[192:195]
    ds_read_b128 a[72:75], v19 offset:15360
    v_mfma_f32_16x16x32_bf16 v[196:199], a[184:187], a[20:23], v[196:199]
    v_mfma_f32_16x16x32_bf16 v[196:199], a[188:191], a[24:27], v[196:199]
    s_mov_b32 s45, s42
    s_add_u32 s42, s42, 27648
    v_mfma_f32_16x16x32_bf16 v[196:199], a[192:195], a[28:31], v[196:199]
    s_cmp_eq_u32 s42, 148480
    s_cselect_b32 s42, 65536, s42
    v_mfma_f32_16x16x32_bf16 v[200:203], a[192:195], a[32:35], v[200:203]
    s_add_u32 s40, s40, 36864
    v_add_u32 v17, s42, v16
    v_mfma_f32_16x16x32_bf16 v[200:203], a[188:191], a[28:31], v[200:203]
    v_add_u32 v21, s42, v20
    v_mfma_f32_16x16x32_bf16 v[200:203], a[184:187], a[24:27], v[200:203]
    s_add_u32 s41, s41, 128
    v_xor_b32 v18, 32768, v18
    v_mfma_f32_16x16x32_bf16 v[204:207], a[184:187], a[28:31], v[204:207]
    s_xor_b32 s43, s43, 32768
    v_xor_b32 v19, 32768, v19
    v_mfma_f32_16x16x32_bf16 v[204:207], a[188:191], a[32:35], v[204:207]
    s_waitcnt vmcnt(16) lgkmcnt(0)
L_mid2:
    s_barrier
    v_mfma_f32_16x16x32_bf16 v[208:211], a[204:207], a[8:11], v[208:211]
    ds_read_b64_tr_b16 a[160:161], v17 offset:0
    v_mfma_f32_16x16x32_bf16 v[208:211], a[200:203], a[4:7], v[208:211]
    v_mfma_f32_16x16x32_bf16 v[208:211], a[196:199], a[0:3], v[208:211]
    s_add_u32 m0, s45, 14336
    v_mfma_f32_16x16x32_bf16 v[212:215], a[196:199], a[4:7], v[212:215]
    buffer_load_dwordx4 v1, s[24:27], s40 offen offset:0 lds
    v_mfma_f32_16x16x32_bf16 v[212:215], a[200:203], a[8:11], v[212:215]
    ds_read_b64_tr_b16 a[162:163], v17 offset:2304
    v_mfma_f32_16x16x32_bf16 v[212:215], a[204:207], a[12:15], v[212:215]
    v_mfma_f32_16x16x32_bf16 v[216:219], a[204:207], a[16:19], v[216:219]
    v_mfma_f32_16x16x32_bf16 v[216:219], a[200:203], a[12:15], v[216:219]
    buffer_load_dwordx4 v2, s[24:27], s40 offen offset:1024 lds
    v_mfma_f32_16x16x32_bf16 v[216:219], a[196:199], a[8:11], v[216:219]
    ds_read_b64_tr_b16 a[164:165], v17 offset:9216
    v_mfma_f32_16x16x32_bf16 v[220:223], a[196:199], a[12:15], v[220:223]
    v_mfma_f32_16x16x32_bf16 v[220:223], a[200:203], a[16:19], v[220:223]
    v_mfma_f32_16x16x32_bf16 v[220:223], a[204:207], a[20:23], v[220:223]
    buffer_load_dwordx4 v3, s[24:27], s40 offen offset:2048 lds
    v_mfma_f32_16x16x32_bf16 v[224:227], a[204:207], a[24:27], v[224:227]
    ds_read_b64_tr_b16 a[166:167], v17 offset:11520
    v_mfma_f32_16x16x32_bf16 v[224:227], a[200:203], a[20:23], v[224:227]
    v_mfma_f32_16x16x32_bf16 v[224:227], a[196:199], a[16:19], v[224:227]
    v_mfma_f32_16x16x32_bf16 v[228:231], a[196:199], a[20:23], v[228:231]
    buffer_load_dwordx4 v4, s[24:27], s40 offen offset:3072 lds
    v_mfma_f32_16x16x32_bf16 v[228:231], a[200:203], a[24:27], v[228:231]
    ds_read_b64_tr_b16 a[168:169], v17 offset:18432
    v_mfma_f32_16x16x32_bf16 v[228:231], a[204:207], a[28:31], v[228:231]
    v_mfma_f32_16x16x32_bf16 v[232:235], a[204:207], a[32:35], v[232:235]
    s_add_u32 m0, s45, 18432
    v_mfma_f32_16x16x32_bf16 v[232:235], a[200:203], a[28:31], v[232:235]
    buffer_load_dwordx4 v5, s[24:27], s40 offen offset:0 lds
    v_mfma_f32_16x16x32_bf16 v[232:235], a[196:199], a[24:27], v[232:235]
    ds_read_b64_tr_b16 a[170:171], v17 offset:20736
    v_mfma_f32_16x16x32_bf16 v[236:239], a[196:199], a[28:31], v[236:239]
    v_mfma_f32_16x16x32_bf16 v[236:239], a[200:203], a[32:35], v[236:239]
    v_mfma_f32_16x16x32_bf16 v[240:243], a[216:219], a[8:11], v[240:243]
    buffer_load_dwordx4 v6, s[24:27], s40 offen offset:1024 lds
    v_mfma_f32_16x16x32_bf16 v[240:243], a[212:215], a[4:7], v[240:243]
    v_mfma_f32_16x16x32_bf16 v[240:243], a[208:211], a[0:3], v[240:243]
    v_mfma_f32_16x16x32_bf16 v[244:247], a[208:211], a[4:7], v[244:247]
    v_mfma_f32_16x16x32_bf16 v[244:247], a[212:215], a[8:11], v[244:247]
    buffer_load_dwordx4 v7, s[24:27], s40 offen offset:2048 lds
    v_mfma_f32_16x16x32_bf16 v[244:247], a[216:219], a[12:15], v[244:247]
    v_mfma_f32_16x16x32_bf16 v[248:251], a[216:219], a[16:19], v[248:251]
    v_mfma_f32_16x16x32_bf16 v[248:251], a[212:215], a[12:15], v[248:251]
    v_mfma_f32_16x16x32_bf16 v[248:251], a[208:211], a[8:11], v[248:251]
    v_mfma_f32_16x16x32_bf16 v[252:255], a[208:211], a[12:15], v[252:255]
    v_mfma_f32_16x16x32_bf16 v[252:255], a[212:215], a[16:19], v[252:255]
    v_mfma_f32_16x16x32_bf16 v[252:255], a[216:219], a[20:23], v[252:255]
    s_waitcnt lgkmcnt(0)
    v_mfma_f32_16x16x32_bf16 v[112:115], a[168:171], a[48:51], v[112:115]
    ds_read_b64_tr_b16 a[172:173], v17 offset:32
    v_mfma_f32_16x16x32_bf16 v[112:115], a[164:167], a[44:47], v[112:115]
    v_mfma_f32_16x16x32_bf16 v[112:115], a[160:163], a[40:43], v[112:115]
    ds_read_b64_tr_b16 a[174:175], v17 offset:2336
    v_mfma_f32_16x16x32_bf16 v[116:119], a[160:163], a[44:47], v[116:119]
    v_mfma_f32_16x16x32_bf16 v[116:119], a[164:167], a[48:51], v[116:119]
    s_add_u32 m0, s43, 8192
    v_mfma_f32_16x16x32_bf16 v[116:119], a[168:171], a[52:55], v[116:119]
    buffer_load_dwordx4 v8, s[20:23], s41 offen offset:0 lds
    v_mfma_f32_16x16x32_bf16 v[120:123], a[168:171], a[56:59], v[120:123]
    ds_read_b64_tr_b16 a[176:177], v17 offset:9248
    v_mfma_f32_16x16x32_bf16 v[120:123], a[164:167], a[52:55], v[120:123]
    v_mfma_f32_16x16x32_bf16 v[120:123], a[160:163], a[48:51], v[120:123]
    ds_read_b64_tr_b16 a[178:179], v17 offset:11552
    v_mfma_f32_16x16x32_bf16 v[124:127], a[160:163], a[52:55], v[124:127]
    v_mfma_f32_16x16x32_bf16 v[124:127], a[164:167], a[56:59], v[124:127]
    v_mfma_f32_16x16x32_bf16 v[124:127], a[168:171], a[60:63], v[124:127]
    buffer_load_dwordx4 v9, s[20:23], s41 offen offset:1024 lds
    v_mfma_f32_16x16x32_bf16 v[128:131], a[168:171], a[64:67], v[128:131]
    ds_read_b64_tr_b16 a[180:181], v17 offset:18464
    v_mfma_f32_16x16x32_bf16 v[128:131], a[164:167], a[60:63], v[128:131]
    v_mfma_f32_16x16x32_bf16 v[128:131], a[160:163], a[56:59], v[128:131]
    ds_read_b64_tr_b16 a[182:183], v17 offset:20768
    v_mfma_f32_16x16x32_bf16 v[132:135], a[160:163], a[60:63], v[132:135]
    v_mfma_f32_16x16x32_bf16 v[132:135], a[164:167], a[64:67], v[132:135]
    v_mfma_f32_16x16x32_bf16 v[132:135], a[168:171], a[68:71], v[132:135]
    buffer_load_dwordx4 v10, s[20:23], s41 offen offset:2048 lds
    v_mfma_f32_16x16x32_bf16 v[136:139], a[168:171], a[72:75], v[136:139]
    v_mfma_f32_16x16x32_bf16 v[136:139], a[164:167], a[68:71], v[136:139]
    v_mfma_f32_16x16x32_bf16 v[136:139], a[160:163], a[64:67], v[136:139]
    v_mfma_f32_16x16x32_bf16 v[140:143], a[160:163], a[68:71], v[140:143]
    v_mfma_f32_16x16x32_bf16 v[140:143], a[164:167], a[72:75], v[140:143]
    s_waitcnt lgkmcnt(0)
    v_mfma_f32_16x16x32_bf16 v[144:147], a[180:183], a[48:51], v[144:147]
    buffer_load_dwordx4 v11, s[20:23], s41 offen offset:3072 lds
    v_mfma_f32_16x16x32_bf16 v[144:147], a[176:179], a[44:47], v[144:147]
    ds_read_b64_tr_b16 a[184:185], v17 offset:64
    v_mfma_f32_16x16x32_bf16 v[144:147], a[172:175], a[40:43], v[144:147]
    v_mfma_f32_16x16x32_bf16 v[148:151], a[172:175], a[44:47], v[148:151]
    ds_read_b64_tr_b16 a[186:187], v17 offset:2368
    v_mfma_f32_16x16x32_bf16 v[148:151], a[176:179], a[48:51], v[148:151]
    v_mfma_f32_16x16x32_bf16 v[148:151], a[180:183], a[52:55], v[148:151]
    s_add_u32 m0, s43, 24576
    ds_read_b64_tr_b16 a[188:189], v17 offset:9280
    v_mfma_f32_16x16x32_bf16 v[152:155], a[180:183], a[56:59], v[152:155]
    buffer_load_dwordx4 v12, s[20:23], s41 offen offset:0 lds
    v_mfma_f32_16x16x32_bf16 v[152:155], a[176:179], a[52:55], v[152:155]
    v_mfma_f32_16x16x32_bf16 v[152:155], a[172:175], a[48:51], v[152:155]
    v_mfma_f32_16x16x32_bf16 v[156:159], a[172:175], a[52:55], v[156:159]
    ds_read_b64_tr_b16 a[190:191], v17 offset:11584
    v_mfma_f32_16x16x32_bf16 v[156:159], a[176:179], a[56:59], v[156:159]
    v_mfma_f32_16x16x32_bf16 v[156:159], a[180:183], a[60:63], v[156:159]
    ds_read_b64_tr_b16 a[192:193], v17 offset:18496
    v_mfma_f32_16x16x32_bf16 v[160:163], a[180:183], a[64:67], v[160:163]
    buffer_load_dwordx4 v13, s[20:23], s41 offen offset:1024 lds
    v_mfma_f32_16x16x32_bf16 v[160:163], a[176:179], a[60:63], v[160:163]
    v_mfma_f32_16x16x32_bf16 v[160:163], a[172:175], a[56:59], v[160:163]
    ds_read_b64_tr_b16 a[194:195], v17 offset:20800
    v_mfma_f32_16x16x32_bf16 v[164:167], a[172:175], a[60:63], v[164:167]
    v_mfma_f32_16x16x32_bf16 v[164:167], a[176:179], a[64:67], v[164:167]
    v_mfma_f32_16x16x32_bf16 v[164:167], a[180:183], a[68:71], v[164:167]
    v_mfma_f32_16x16x32_bf16 v[168:171], a[180:183], a[72:75], v[168:171]
    buffer_load_dwordx4 v14, s[20:23], s41 offen offset:2048 lds
    v_mfma_f32_16x16x32_bf16 v[168:171], a[176:179], a[68:71], v[168:171]
    v_mfma_f32_16x16x32_bf16 v[168:171], a[172:175], a[64:67], v[168:171]
    v_mfma_f32_16x16x32_bf16 v[172:175], a[172:175], a[68:71], v[172:175]
    v_mfma_f32_16x16x32_bf16 v[172:175], a[176:179], a[72:75], v[172:175]
    s_waitcnt lgkmcnt(0)
    v_mfma_f32_16x16x32_bf16 v[176:179], a[192:195], a[48:51], v[176:179]
    ds_read_b64_tr_b16 a[196:197], v17 offset:96
    v_mfma_f32_16x16x32_bf16 v[176:179], a[188:191], a[44:47], v[176:179]
    buffer_load_dwordx4 v15, s[20:23], s41 offen offset:3072 lds
    v_mfma_f32_16x16x32_bf16 v[176:179], a[184:187], a[40:43], v[176:179]
    ds_read_b64_tr_b16 a[198:199], v17 offset:2400
    v_mfma_f32_16x16x32_bf16 v[180:183], a[184:187], a[44:47], v[180:183]
    ds_read_b64_tr_b16 a[200:201], v17 offset:9312
    v_mfma_f32_16x16x32_bf16 v[180:183], a[188:191], a[48:51], v[180:183]
    ds_read_b64_tr_b16 a[202:203], v17 offset:11616
    v_mfma_f32_16x16x32_bf16 v[180:183], a[192:195], a[52:55], v[180:183]
    v_mfma_f32_16x16x32_bf16 v[184:187], a[192:195], a[56:59], v[184:187]
    ds_read_b64_tr_b16 a[204:205], v17 offset:18528
    v_mfma_f32_16x16x32_bf16 v[184:187], a[188:191], a[52:55], v[184:187]
    ds_read_b64_tr_b16 a[206:207], v17 offset:20832
    v_mfma_f32_16x16x32_bf16 v[184:187], a[184:187], a[48:51], v[184:187]
    ds_read_b64_tr_b16 a[208:209], v21 offset:0
    v_mfma_f32_16x16x32_bf16 v[188:191], a[184:187], a[52:55], v[188:191]
    ds_read_b64_tr_b16 a[210:211], v21 offset:2304
    v_mfma_f32_16x16x32_bf16 v[188:191], a[188:191], a[56:59], v[188:191]
    v_mfma_f32_16x16x32_bf16 v[188:191], a[192:195], a[60:63], v[188:191]
    ds_read_b64_tr_b16 a[212:213], v21 offset:9216
    v_mfma_f32_16x16x32_bf16 v[192:195], a[192:195], a[64:67], v[192:195]
    ds_read_b64_tr_b16 a[214:215], v21 offset:11520
    v_mfma_f32_16x16x32_bf16 v[192:195], a[188:191], a[60:63], v[192:195]
    ds_read_b64_tr_b16 a[216:217], v21 offset:18432
    v_mfma_f32_16x16x32_bf16 v[192:195], a[184:187], a[56:59], v[192:195]
    ds_read_b64_tr_b16 a[218:219], v21 offset:20736
    v_mfma_f32_16x16x32_bf16 v[196:199], a[184:187], a[60:63], v[196:199]
    v_mfma_f32_16x16x32_bf16 v[196:199], a[188:191], a[64:67], v[196:199]
    s_mov_b32 s45, s42
    s_add_u32 s42, s42, 27648
    v_mfma_f32_16x16x32_bf16 v[196:199], a[192:195], a[68:71], v[196:199]
    s_cmp_eq_u32 s42, 148480
    s_cselect_b32 s42, 65536, s42
    v_mfma_f32_16x16x32_bf16 v[200:203], a[192:195], a[72:75], v[200:203]
    s_add_u32 s40, s40, 36864
    v_add_u32 v17, s42, v16
    v_mfma_f32_16x16x32_bf16 v[200:203], a[188:191], a[68:71], v[200:203]
    v_add_u32 v21, s42, v20
    v_mfma_f32_16x16x32_bf16 v[200:203], a[184:187], a[64:67], v[200:203]
    v_mfma_f32_16x16x32_bf16 v[204:207], a[184:187], a[68:71], v[204:207]
    v_mfma_f32_16x16x32_bf16 v[204:207], a[188:191], a[72:75], v[204:207]
    s_waitcnt vmcnt(16) lgkmcnt(0)
    s_barrier
    v_mfma_f32_16x16x32_bf16 v[208:211], a[204:207], a[48:51], v[208:211]
    ds_read_b64_tr_b16 a[160:161], v17 offset:0
    v_mfma_f32_16x16x32_bf16 v[208:211], a[200:203], a[44:47], v[208:211]
    ds_read_b64_tr_b16 a[162:163], v17 offset:2304
    v_mfma_f32_16x16x32_bf16 v[208:211], a[196:199], a[40:43], v[208:211]
    s_add_u32 m0, s45, 14336
    ds_read_b64_tr_b16 a[164:165], v17 offset:9216
    v_mfma_f32_16x16x32_bf16 v[212:215], a[196:199], a[44:47], v[212:215]
    buffer_load_dwordx4 v1, s[24:27], s40 offen offset:0 lds
    v_mfma_f32_16x16x32_bf16 v[212:215], a[200:203], a[48:51], v[212:215]
    ds_read_b64_tr_b16 a[166:167], v17 offset:11520
    v_mfma_f32_16x16x32_bf16 v[212:215], a[204:207], a[52:55], v[212:215]
    ds_read_b64_tr_b16 a[168:169], v17 offset:18432
    v_mfma_f32_16x16x32_bf16 v[216:219], a[204:207], a[56:59], v[216:219]
    v_mfma_f32_16x16x32_bf16 v[216:219], a[200:203], a[52:55], v[216:219]
    buffer_load_dwordx4 v2, s[24:27], s40 offen offset:1024 lds
    v_mfma_f32_16x16x32_bf16 v[216:219], a[196:199], a[48:51], v[216:219]
    ds_read_b64_tr_b16 a[170:171], v17 offset:20736
    v_mfma_f32_16x16x32_bf16 v[220:223], a[196:199], a[52:55], v[220:223]
    ds_read_b128 a[0:3], v18 offset:7168
    v_mfma_f32_16x16x32_bf16 v[220:223], a[200:203], a[56:59], v[220:223]
    ds_read_b128 a[4:7], v18 offset:8192
    v_mfma_f32_16x16x32_bf16 v[220:223], a[204:207], a[60:63], v[220:223]
    buffer_load_dwordx4 v3, s[24:27], s40 offen offset:2048 lds
    v_mfma_f32_16x16x32_bf16 v[224:227], a[204:207], a[64:67], v[224:227]
    ds_read_b128 a[8:11], v18 offset:9216
    v_mfma_f32_16x16x32_bf16 v[224:227], a[200:203], a[60:63], v[224:227]
    ds_read_b128 a[12:15], v18 offset:10240
    v_mfma_f32_16x16x32_bf16 v[224:227], a[196:199], a[56:59], v[224:227]
    v_mfma_f32_16x16x32_bf16 v[228:231], a[196:199], a[60:63], v[228:231]
    buffer_load_dwordx4 v4, s[24:27], s40 offen offset:3072 lds
    v_mfma_f32_16x16x32_bf16 v[228:231], a[200:203], a[64:67], v[228:231]
    ds_read_b128 a[16:19], v18 offset:11264
    v_mfma_f32_16x16x32_bf16 v[228:231], a[204:207], a[68:71], v[228:231]
    ds_read_b128 a[20:23], v18 offset:12288
    v_mfma_f32_16x16x32_bf16 v[232:235], a[204:207], a[72:75], v[232:235]
    s_add_u32 m0, s45, 18432
    ds_read_b128 a[24:27], v18 offset:13312
    v_mfma_f32_16x16x32_bf16 v[232:235], a[200:203], a[68:71], v[232:235]
    buffer_load_dwordx4 v5, s[24:27], s40 offen offset:0 lds
    v_mfma_f32_16x16x32_bf16 v[232:235], a[196:199], a[64:67], v[232:235]
    ds_read_b128 a[28:31], v18 offset:14336
    v_mfma_f32_16x16x32_bf16 v[236:239], a[196:199], a[68:71], v[236:239]
    ds_read_b128 a[32:35], v18 offset:15360
    v_mfma_f32_16x16x32_bf16 v[236:239], a[200:203], a[72:75], v[236:239]
    v_mfma_f32_16x16x32_bf16 v[240:243], a[216:219], a[48:51], v[240:243]
    buffer_load_dwordx4 v6, s[24:27], s40 offen offset:1024 lds
    v_mfma_f32_16x16x32_bf16 v[240:243], a[212:215], a[44:47], v[240:243]
    v_mfma_f32_16x16x32_bf16 v[240:243], a[208:211], a[40:43], v[240:243]
    v_mfma_f32_16x16x32_bf16 v[244:247], a[208:211], a[44:47], v[244:247]
    v_mfma_f32_16x16x32_bf16 v[244:247], a[212:215], a[48:51], v[244:247]
    buffer_load_dwordx4 v7, s[24:27], s40 offen offset:2048 lds
    v_mfma_f32_16x16x32_bf16 v[244:247], a[216:219], a[52:55], v[244:247]
    v_mfma_f32_16x16x32_bf16 v[248:251], a[216:219], a[56:59], v[248:251]
    v_mfma_f32_16x16x32_bf16 v[248:251], a[212:215], a[52:55], v[248:251]
    v_mfma_f32_16x16x32_bf16 v[248:251], a[208:211], a[48:51], v[248:251]
    v_mfma_f32_16x16x32_bf16 v[252:255], a[208:211], a[52:55], v[252:255]
    v_mfma_f32_16x16x32_bf16 v[252:255], a[212:215], a[56:59], v[252:255]
    s_add_u32 s44, s44, 1
    s_cmp_eq_u32 s44, 7
    v_mfma_f32_16x16x32_bf16 v[252:255], a[216:219], a[60:63], v[252:255]
    s_cbranch_scc0 L_loop2
    s_branch L_tail
.if (. - L_w2) > 4096
.error "variant page overflow"
.endif
.p2align 12
L_w3:
    s_cbranch_vccnz L_backA
    s_waitcnt vmcnt(10)
    s_barrier
    ds_read_b64_tr_b16 a[168:169], v17 offset:18432
    ds_read_b64_tr_b16 a[170:171], v17 offset:20736
    ds_read_b128 a[8:11], v18 offset:9216
    ds_read_b64_tr_b16 a[164:165], v17 offset:9216
    ds_read_b64_tr_b16 a[166:167], v17 offset:11520
    ds_read_b128 a[4:7], v18 offset:8192
    ds_read_b64_tr_b16 a[160:161], v17 offset:0
    ds_read_b64_tr_b16 a[162:163], v17 offset:2304
    ds_read_b128 a[0:3], v18 offset:7168
    ds_read_b128 a[12:15], v18 offset:10240
    ds_read_b128 a[16:19], v18 offset:11264
    ds_read_b128 a[20:23], v18 offset:12288
    ds_read_b128 a[24:27], v18 offset:13312
    ds_read_b128 a[28:31], v18 offset:14336
    ds_read_b128 a[32:35], v18 offset:15360
    s_waitcnt lgkmcnt(12)
    v_mfma_f32_16x16x32_bf16 v[112:115], a[168:171], a[8:11], 0
    s_waitcnt lgkmcnt(9)
    v_mfma_f32_16x16x32_bf16 v[112:115], a[164:167], a[4:7], v[112:115]
    s_waitcnt lgkmcnt(6)
    v_mfma_f32_16x16x32_bf16 v[112:115], a[160:163], a[0:3], v[112:115]
    v_mfma_f32_16x16x32_bf16 v[116:119], a[160:163], a[4:7], 0
    s_add_u32 m0, s43, 12288
    ds_read_b64_tr_b16 a[172:173], v17 offset:32
    v_mfma_f32_16x16x32_bf16 v[116:119], a[164:167], a[8:11], v[116:119]
    buffer_load_dwordx4 v8, s[20:23], s41 offen offset:0 lds
    ds_read_b64_tr_b16 a[174:175], v17 offset:2336
    s_waitcnt lgkmcnt(6)
    v_mfma_f32_16x16x32_bf16 v[116:119], a[168:171], a[12:15], v[116:119]
    v_mfma_f32_16x16x32_bf16 v[120:123], a[168:171], a[16:19], 0
    ds_read_b64_tr_b16 a[176:177], v17 offset:9248
    v_mfma_f32_16x16x32_bf16 v[120:123], a[164:167], a[12:15], v[120:123]
    v_mfma_f32_16x16x32_bf16 v[120:123], a[160:163], a[8:11], v[120:123]
    buffer_load_dwordx4 v9, s[20:23], s41 offen offset:1024 lds
    ds_read_b64_tr_b16 a[178:179], v17 offset:11552
    v_mfma_f32_16x16x32_bf16 v[124:127], a[160:163], a[12:15], 0
    ds_read_b64_tr_b16 a[180:181], v17 offset:18464
    v_mfma_f32_16x16x32_bf16 v[124:127], a[164:167], a[16:19], v[124:127]
    ds_read_b64_tr_b16 a[182:183], v17 offset:20768
    s_waitcnt lgkmcnt(6)
    v_mfma_f32_16x16x32_bf16 v[124:127], a[168:171], a[20:23], v[124:127]
    v_mfma_f32_16x16x32_bf16 v[128:131], a[168:171], a[24:27], 0
    buffer_load_dwordx4 v10, s[20:23], s41 offen offset:2048 lds
    ds_read_b128 a[40:43], v19 offset:7168
    v_mfma_f32_16x16x32_bf16 v[128:131], a[164:167], a[20:23], v[128:131]
    v_mfma_f32_16x16x32_bf16 v[128:131], a[160:163], a[16:19], v[128:131]
    ds_read_b128 a[44:47], v19 offset:8192
    v_mfma_f32_16x16x32_bf16 v[132:135], a[160:163], a[20:23], 0
    ds_read_b128 a[48:51], v19 offset:9216
    v_mfma_f32_16x16x32_bf16 v[132:135], a[164:167], a[24:27], v[132:135]
    buffer_load_dwordx4 v11, s[20:23], s41 offen offset:3072 lds
    v_mfma_f32_16x16x32_bf16 v[132:135], a[168:171], a[28:31], v[132:135]
    v_mfma_f32_16x16x32_bf16 v[136:139], a[168:171], a[32:35], 0
    v_mfma_f32_16x16x32_bf16 v[136:139], a[164:167], a[28:31], v[136:139]
    s_add_u32 m0, s43, 28672
    v_mfma_f32_16x16x32_bf16 v[136:139], a[160:163], a[24:27], v[136:139]
    buffer_load_dwordx4 v12, s[20:23], s41 offen offset:0 lds
    v_mfma_f32_16x16x32_bf16 v[140:143], a[160:163], a[28:31], 0
    v_mfma_f32_16x16x32_bf16 v[140:143], a[164:167], a[32:35], v[140:143]
    s_waitcnt lgkmcnt(0)
    v_mfma_f32_16x16x32_bf16 v[144:147], a[180:183], a[8:11], 0
    ds_read_b64_tr_b16 a[184:185], v17 offset:64
    v_mfma_f32_16x16x32_bf16 v[144:147], a[176:179], a[4:7], v[144:147]
    buffer_load_dwordx4 v13, s[20:23], s41 offen offset:1024 lds
    v_mfma_f32_16x16x32_bf16 v[144:147], a[172:175], a[0:3], v[144:147]
    ds_read_b64_tr_b16 a[186:187], v17 offset:2368
    v_mfma_f32_16x16x32_bf16 v[148:151], a[172:175], a[4:7], 0
    ds_read_b64_tr_b16 a[188:189], v17 offset:9280
    v_mfma_f32_16x16x32_bf16 v[148:151], a[176:179], a[8:11], v[148:151]
    v_mfma_f32_16x16x32_bf16 v[148:151], a[180:183], a[12:15], v[148:151]
    buffer_load_dwordx4 v14, s[20:23], s41 offen offset:2048 lds
    v_mfma_f32_16x16x32_bf16 v[152:155], a[180:183], a[16:19], 0
    ds_read_b64_tr_b16 a[190:191], v17 offset:11584
    v_mfma_f32_16x16x32_bf16 v[152:155], a[176:179], a[12:15], v[152:155]
    ds_read_b64_tr_b16 a[192:193], v17 offset:18496
    v_mfma_f32_16x16x32_bf16 v[152:155], a[172:175], a[8:11], v[152:155]
    v_mfma_f32_16x16x32_bf16 v[156:159], a[172:175], a[12:15], 0
    ds_read_b64_tr_b16 a[194:195], v17 offset:20800
    v_mfma_f32_16x16x32_bf16 v[156:159], a[176:179], a[16:19], v[156:159]
    buffer_load_dwordx4 v15, s[20:23], s41 offen offset:3072 lds
    v_mfma_f32_16x16x32_bf16 v[156:159], a[180:183], a[20:23], v[156:159]
    ds_read_b128 a[52:55], v19 offset:10240
    v_mfma_f32_16x16x32_bf16 v[160:163], a[180:183], a[24:27], 0
    v_mfma_f32_16x16x32_bf16 v[160:163], a[176:179], a[20:23], v[160:163]
    s_add_u32 m0, s45, 21504
    ds_read_b128 a[56:59], v19 offset:11264
    v_mfma_f32_16x16x32_bf16 v[160:163], a[172:175], a[16:19], v[160:163]
    buffer_load_dwordx4 v1, s[24:27], s40 offen offset:0 lds
    v_mfma_f32_16x16x32_bf16 v[164:167], a[172:175], a[20:23], 0
    ds_read_b128 a[60:63], v19 offset:12288
    v_mfma_f32_16x16x32_bf16 v[164:167], a[176:179], a[24:27], v[164:167]
    v_mfma_f32_16x16x32_bf16 v[164:167], a[180:183], a[28:31], v[164:167]
    v_mfma_f32_16x16x32_bf16 v[168:171], a[180:183], a[32:35], 0
    buffer_load_dwordx4 v2, s[24:27], s40 offen offset:1024 lds
    v_mfma_f32_16x16x32_bf16 v[168:171], a[176:179], a[28:31], v[168:171]
    v_mfma_f32_16x16x32_bf16 v[168:171], a[172:175], a[24:27], v[168:171]
    v_mfma_f32_16x16x32_bf16 v[172:175], a[172:175], a[28:31], 0
    v_mfma_f32_16x16x32_bf16 v[172:175], a[176:179], a[32:35], v[172:175]
    buffer_load_dwordx4 v3, s[24:27], s40 offen offset:2048 lds
    s_waitcnt lgkmcnt(0)
    v_mfma_f32_16x16x32_bf16 v[176:179], a[192:195], a[8:11], 0
    ds_read_b64_tr_b16 a[196:197], v17 offset:96
    v_mfma_f32_16x16x32_bf16 v[176:179], a[188:191], a[4:7], v[176:179]
    ds_read_b64_tr_b16 a[198:199], v17 offset:2400
    v_mfma_f32_16x16x32_bf16 v[176:179], a[184:187], a[0:3], v[176:179]
    ds_read_b64_tr_b16 a[200:201], v17 offset:9312
    v_mfma_f32_16x16x32_bf16 v[180:183], a[184:187], a[4:7], 0
    buffer_load_dwordx4 v4, s[24:27], s40 offen offset:3072 lds
    ds_read_b64_tr_b16 a[202:203], v17 offset:11616
    v_mfma_f32_16x16x32_bf16 v[180:183], a[188:191], a[8:11], v[180:183]
    ds_read_b64_tr_b16 a[204:205], v17 offset:18528
    v_mfma_f32_16x16x32_bf16 v[180:183], a[192:195], a[12:15], v[180:183]
    ds_read_b64_tr_b16 a[206:207], v17 offset:20832
    v_mfma_f32_16x16x32_bf16 v[184:187], a[192:195], a[16:19], 0
    s_add_u32 m0, s45, 25600
    ds_read_b64_tr_b16 a[208:209], v21 offset:0
    v_mfma_f32_16x16x32_bf16 v[184:187], a[188:191], a[12:15], v[184:187]
    buffer_load_dwordx4 v5, s[24:27], s40 offen offset:0 lds
    ds_read_b64_tr_b16 a[210:211], v21 offset:2304
    v_mfma_f32_16x16x32_bf16 v[184:187], a[184:187], a[8:11], v[184:187]
    ds_read_b64_tr_b16 a[212:213], v21 offset:9216
    v_mfma_f32_16x16x32_bf16 v[188:191], a[184:187], a[12:15], 0
    ds_read_b64_tr_b16 a[214:215], v21 offset:11520
    v_mfma_f32_16x16x32_bf16 v[188:191], a[188:191], a[16:19], v[188:191]
    ds_read_b64_tr_b16 a[216:217], v21 offset:18432
    v_mfma_f32_16x16x32_bf16 v[188:191], a[192:195], a[20:23], v[188:191]
    buffer_load_dwordx4 v6, s[24:27], s40 offen offset:1024 lds
    ds_read_b64_tr_b16 a[218:219], v21 offset:20736
    v_mfma_f32_16x16x32_bf16 v[192:195], a[192:195], a[24:27], 0
    ds_read_b128 a[64:67], v19 offset:13312
    v_mfma_f32_16x16x32_bf16 v[192:195], a[188:191], a[20:23], v[192:195]
    ds_read_b128 a[68:71], v19 offset:14336
    v_mfma_f32_16x16x32_bf16 v[192:195], a[184:187], a[16:19], v[192:195]
    ds_read_b128 a[72:75], v19 offset:15360
    v_mfma_f32_16x16x32_bf16 v[196:199], a[184:187], a[20:23], 0
    v_mfma_f32_16x16x32_bf16 v[196:199], a[188:191], a[24:27], v[196:199]
    s_mov_b32 s45, s42
    s_add_u32 s42, s42, 27648
    v_mfma_f32_16x16x32_bf16 v[196:199], a[192:195], a[28:31], v[196:199]
    s_cmp_eq_u32 s42, 148480
    s_cselect_b32 s42, 65536, s42
    v_mfma_f32_16x16x32_bf16 v[200:203], a[192:195], a[32:35], 0
    s_add_u32 s40, s40, 36864
    v_add_u32 v17, s42, v16
    v_mfma_f32_16x16x32_bf16 v[200:203], a[188:191], a[28:31], v[200:203]
    v_add_u32 v21, s42, v20
    v_mfma_f32_16x16x32_bf16 v[200:203], a[184:187], a[24:27], v[200:203]
    s_add_u32 s41, s41, 128
    v_xor_b32 v18, 32768, v18
    v_mfma_f32_16x16x32_bf16 v[204:207], a[184:187], a[28:31], 0
    s_xor_b32 s43, s43, 32768
    v_xor_b32 v19, 32768, v19
    v_mfma_f32_16x16x32_bf16 v[204:207], a[188:191], a[32:35], v[204:207]
    s_waitcnt vmcnt(18) lgkmcnt(0)
    s_branch L_mid3
L_loop3:
    s_waitcnt lgkmcnt(0)
    v_mfma_f32_16x16x32_bf16 v[112:115], a[168:171], a[8:11], v[112:115]
    ds_read_b64_tr_b16 a[172:173], v17 offset:32
    v_mfma_f32_16x16x32_bf16 v[112:115], a[164:167], a[4:7], v[112:115]
    ds_read_b64_tr_b16 a[174:175], v17 offset:2336
    v_mfma_f32_16x16x32_bf16 v[112:115], a[160:163], a[0:3], v[112:115]
    v_mfma_f32_16x16x32_bf16 v[116:119], a[160:163], a[4:7], v[116:119]
    ds_read_b64_tr_b16 a[176:177], v17 offset:9248
    v_mfma_f32_16x16x32_bf16 v[116:119], a[164:167], a[8:11], v[116:119]
    v_mfma_f32_16x16x32_bf16 v[116:119], a[168:171], a[12:15], v[116:119]
    ds_read_b64_tr_b16 a[178:179], v17 offset:11552
    v_mfma_f32_16x16x32_bf16 v[120:123], a[168:171], a[16:19], v[120:123]
    v_mfma_f32_16x16x32_bf16 v[120:123], a[164:167], a[12:15], v[120:123]
    ds_read_b64_tr_b16 a[180:181], v17 offset:18464
    v_mfma_f32_16x16x32_bf16 v[120:123], a[160:163], a[8:11], v[120:123]
    v_mfma_f32_16x16x32_bf16 v[124:127], a[160:163], a[12:15], v[124:127]
    ds_read_b64_tr_b16 a[182:183], v17 offset:20768
    v_mfma_f32_16x16x32_bf16 v[124:127], a[164:167], a[16:19], v[124:127]
    v_mfma_f32_16x16x32_bf16 v[124:127], a[168:171], a[20:23], v[124:127]
    ds_read_b128 a[40:43], v19 offset:7168
    v_mfma_f32_16x16x32_bf16 v[128:131], a[168:171], a[24:27], v[128:131]
    v_mfma_f32_16x16x32_bf16 v[128:131], a[164:167], a[20:23], v[128:131]
    ds_read_b128 a[44:47], v19 offset:8192
    v_mfma_f32_16x16x32_bf16 v[128:131], a[160:163], a[16:19], v[128:131]
    v_mfma_f32_16x16x32_bf16 v[132:135], a[160:163], a[20:23], v[132:135]
    ds_read_b128 a[48:51], v19 offset:9216
    v_mfma_f32_16x16x32_bf16 v[132:135], a[164:167], a[24:27], v[132:135]
    v_mfma_f32_16x16x32_bf16 v[132:135], a[168:171], a[28:31], v[132:135]
    v_mfma_f32_16x16x32_bf16 v[136:139], a[168:171], a[32:35], v[136:139]
    v_mfma_f32_16x16x32_bf16 v[136:139], a[164:167], a[28:31], v[136:139]
    v_mfma_f32_16x16x32_bf16 v[136:139], a[160:163], a[24:27], v[136:139]
    v_mfma_f32_16x16x32_bf16 v[140:143], a[160:163], a[28:31], v[140:143]
    v_mfma_f32_16x16x32_bf16 v[140:143], a[164:167], a[32:35], v[140:143]
    s_waitcnt lgkmcnt(0)
    v_mfma_f32_16x16x32_bf16 v[144:147], a[180:183], a[8:11], v[144:147]
    ds_read_b64_tr_b16 a[184:185], v17 offset:64
    v_mfma_f32_16x16x32_bf16 v[144:147], a[176:179], a[4:7], v[144:147]
    ds_read_b64_tr_b16 a[186:187], v17 offset:2368
    v_mfma_f32_16x16x32_bf16 v[144:147], a[172:175], a[0:3], v[144:147]
    v_mfma_f32_16x16x32_bf16 v[148:151], a[172:175], a[4:7], v[148:151]
    ds_read_b64_tr_b16 a[188:189], v17 offset:9280
    v_mfma_f32_16x16x32_bf16 v[148:151], a[176:179], a[8:11], v[148:151]
    v_mfma_f32_16x16x32_bf16 v[148:151], a[180:183], a[12:15], v[148:151]
    ds_read_b64_tr_b16 a[190:191], v17 offset:11584
    v_mfma_f32_16x16x32_bf16 v[152:155], a[180:183], a[16:19], v[152:155]
    v_mfma_f32_16x16x32_bf16 v[152:155], a[176:179], a[12:15], v[152:155]
    ds_read_b64_tr_b16 a[192:193], v17 offset:18496
    v_mfma_f32_16x16x32_bf16 v[152:155], a[172:175], a[8:11], v[152:155]
    v_mfma_f32_16x16x32_bf16 v[156:159], a[172:175], a[12:15], v[156:159]
    ds_read_b64_tr_b16 a[194:195], v17 offset:20800
    v_mfma_f32_16x16x32_bf16 v[156:159], a[176:179], a[16:19], v[156:159]
    v_mfma_f32_16x16x32_bf16 v[156:159], a[180:183], a[20:23], v[156:159]
    ds_read_b128 a[52:55], v19 offset:10240
    v_mfma_f32_16x16x32_bf16 v[160:163], a[180:183], a[24:27], v[160:163]
    v_mfma_f32_16x16x32_bf16 v[160:163], a[176:179], a[20:23], v[160:163]
    ds_read_b128 a[56:59], v19 offset:11264
    v_mfma_f32_16x16x32_bf16 v[160:163], a[172:175], a[16:19], v[160:163]
    v_mfma_f32_16x16x32_bf16 v[164:167], a[172:175], a[20:23], v[164:167]
    ds_read_b128 a[60:63], v19 offset:12288
    v_mfma_f32_16x16x32_bf16 v[164:167], a[176:179], a[24:27], v[164:167]
    v_mfma_f32_16x16x32_bf16 v[164:167], a[180:183], a[28:31], v[164:167]
    v_mfma_f32_16x16x32_bf16 v[168:171], a[180:183], a[32:35], v[168:171]
    v_mfma_f32_16x16x32_bf16 v[168:171], a[176:179], a[28:31], v[168:171]
    v_mfma_f32_16x16x32_bf16 v[168:171], a[172:175], a[24:27], v[168:171]
    v_mfma_f32_16x16x32_bf16 v[172:175], a[172:175], a[28:31], v[172:175]
    v_mfma_f32_16x16x32_bf16 v[172:175], a[176:179], a[32:35], v[172:175]
    s_waitcnt lgkmcnt(0)
    v_mfma_f32_16x16x32_bf16 v[176:179], a[192:195], a[8:11], v[176:179]
    ds_read_b64_tr_b16 a[196:197], v17 offset:96
    v_mfma_f32_16x16x32_bf16 v[176:179], a[188:191], a[4:7], v[176:179]
    ds_read_b64_tr_b16 a[198:199], v17 offset:2400
    v_mfma_f32_16x16x32_bf16 v[176:179], a[184:187], a[0:3], v[176:179]
    ds_read_b64_tr_b16 a[200:201], v17 offset:9312
    v_mfma_f32_16x16x32_bf16 v[180:183], a[184:187], a[4:7], v[180:183]
    ds_read_b64_tr_b16 a[202:203], v17 offset:11616
    v_mfma_f32_16x16x32_bf16 v[180:183], a[188:191], a[8:11], v[180:183]
    ds_read_b64_tr_b16 a[204:205], v17 offset:18528
    v_mfma_f32_16x16x32_bf16 v[180:183], a[192:195], a[12:15], v[180:183]
    ds_read_b64_tr_b16 a[206:207], v17 offset:20832
    v_mfma_f32_16x16x32_bf16 v[184:187], a[192:195], a[16:19], v[184:187]
    ds_read_b64_tr_b16 a[208:209], v21 offset:0
    v_mfma_f32_16x16x32_bf16 v[184:187], a[188:191], a[12:15], v[184:187]
    ds_read_b64_tr_b16 a[210:211], v21 offset:2304
    v_mfma_f32_16x16x32_bf16 v[184:187], a[184:187], a[8:11], v[184:187]
    ds_read_b64_tr_b16 a[212:213], v21 offset:9216
    v_mfma_f32_16x16x32_bf16 v[188:191], a[184:187], a[12:15], v[188:191]
    ds_read_b64_tr_b16 a[214:215], v21 offset:11520
    v_mfma_f32_16x16x32_bf16 v[188:191], a[188:191], a[16:19], v[188:191]
    ds_read_b64_tr_b16 a[216:217], v21 offset:18432
    v_mfma_f32_16x16x32_bf16 v[188:191], a[192:195], a[20:23], v[188:191]
    ds_read_b64_tr_b16 a[218:219], v21 offset:20736
    v_mfma_f32_16x16x32_bf16 v[192:195], a[192:195], a[24:27], v[192:195]
    ds_read_b128 a[64:67], v19 offset:13312
    v_mfma_f32_16x16x32_bf16 v[192:195], a[188:191], a[20:23], v[192:195]
    ds_read_b128 a[68:71], v19 offset:14336
    v_mfma_f32_16x16x32_bf16 v[192:195], a[184:187], a[16:19], v[192:195]
    ds_read_b128 a[72:75], v19 offset:15360
    v_mfma_f32_16x16x32_bf16 v[196:199], a[184:187], a[20:23], v[196:199]
    v_mfma_f32_16x16x32_bf16 v[196:199], a[188:191], a[24:27], v[196:199]
    s_mov_b32 s45, s42
    s_add_u32 s42, s42, 27648
    v_mfma_f32_16x16x32_bf16 v[196:199], a[192:195], a[28:31], v[196:199]
    s_cmp_eq_u32 s42, 148480
    s_cselect_b32 s42, 65536, s42
    v_mfma_f32_16x16x32_bf16 v[200:203], a[192:195], a[32:35], v[200:203]
    s_add_u32 s40, s40, 36864
    v_add_u32 v17, s42, v16
    v_mfma_f32_16x16x32_bf16 v[200:203], a[188:191], a[28:31], v[200:203]
    v_add_u32 v21, s42, v20
    v_mfma_f32_16x16x32_bf16 v[200:203], a[184:187], a[24:27], v[200:203]
    s_add_u32 s41, s41, 128
    v_xor_b32 v18, 32768, v18
    v_mfma_f32_16x16x32_bf16 v[204:207], a[184:187], a[28:31], v[204:207]
    s_xor_b32 s43, s43, 32768
    v_xor_b32 v19, 32768, v19
    v_mfma_f32_16x16x32_bf16 v[204:207], a[188:191], a[32:35], v[204:207]
    s_waitcnt vmcnt(14) lgkmcnt(0)
L_mid3:
    s_barrier
    v_mfma_f32_16x16x32_bf16 v[208:211], a[204:207], a[8:11], v[208:211]
    ds_read_b64_tr_b16 a[160:161], v17 offset:0
    v_mfma_f32_16x16x32_bf16 v[208:211], a[200:203], a[4:7], v[208:211]
    v_mfma_f32_16x16x32_bf16 v[208:211], a[196:199], a[0:3], v[208:211]
    v_mfma_f32_16x16x32_bf16 v[212:215], a[196:199], a[4:7], v[212:215]
    s_add_u32 m0, s45, 21504
    ds_read_b64_tr_b16 a[162:163], v17 offset:2304
    v_mfma_f32_16x16x32_bf16 v[212:215], a[200:203], a[8:11], v[212:215]
    buffer_load_dwordx4 v1, s[24:27], s40 offen offset:0 lds
    v_mfma_f32_16x16x32_bf16 v[212:215], a[204:207], a[12:15], v[212:215]
    v_mfma_f32_16x16x32_bf16 v[216:219], a[204:207], a[16:19], v[216:219]
    v_mfma_f32_16x16x32_bf16 v[216:219], a[200:203], a[12:15], v[216:219]
    ds_read_b64_tr_b16 a[164:165], v17 offset:9216
    v_mfma_f32_16x16x32_bf16 v[216:219], a[196:199], a[8:11], v[216:219]
    buffer_load_dwordx4 v2, s[24:27], s40 offen offset:1024 lds
    v_mfma_f32_16x16x32_bf16 v[220:223], a[196:199], a[12:15], v[220:223]
    v_mfma_f32_16x16x32_bf16 v[220:223], a[200:203], a[16:19], v[220:223]
    v_mfma_f32_16x16x32_bf16 v[220:223], a[204:207], a[20:23], v[220:223]
    ds_read_b64_tr_b16 a[166:167], v17 offset:11520
    v_mfma_f32_16x16x32_bf16 v[224:227], a[204:207], a[24:27], v[224:227]
    buffer_load_dwordx4 v3, s[24:27], s40 offen offset:2048 lds
    v_mfma_f32_16x16x32_bf16 v[224:227], a[200:203], a[20:23], v[224:227]
    v_mfma_f32_16x16x32_bf16 v[224:227], a[196:199], a[16:19], v[224:227]
    v_mfma_f32_16x16x32_bf16 v[228:231], a[196:199], a[20:23], v[228:231]
    ds_read_b64_tr_b16 a[168:169], v17 offset:18432
    v_mfma_f32_16x16x32_bf16 v[228:231], a[200:203], a[24:27], v[228:231]
    buffer_load_dwordx4 v4, s[24:27], s40 offen offset:3072 lds
    v_mfma_f32_16x16x32_bf16 v[228:231], a[204:207], a[28:31], v[228:231]
    v_mfma_f32_16x16x32_bf16 v[232:235], a[204:207], a[32:35], v[232:235]
    v_mfma_f32_16x16x32_bf16 v[232:235], a[200:203], a[28:31], v[232:235]
    s_add_u32 m0, s45, 25600
    ds_read_b64_tr_b16 a[170:171], v17 offset:20736
    v_mfma_f32_16x16x32_bf16 v[232:235], a[196:199], a[24:27], v[232:235]
    buffer_load_dwordx4 v5, s[24:27], s40 offen offset:0 lds
    v_mfma_f32_16x16x32_bf16 v[236:239], a[196:199], a[28:31], v[236:239]
    v_mfma_f32_16x16x32_bf16 v[236:239], a[200:203], a[32:35], v[236:239]
    v_mfma_f32_16x16x32_bf16 v[240:243], a[216:219], a[24:27], v[240:243]
    v_mfma_f32_16x16x32_bf16 v[240:243], a[212:215], a[20:23], v[240:243]
    buffer_load_dwordx4 v6, s[24:27], s40 offen offset:1024 lds
    v_mfma_f32_16x16x32_bf16 v[240:243], a[208:211], a[16:19], v[240:243]
    v_mfma_f32_16x16x32_bf16 v[244:247], a[208:211], a[20:23], v[244:247]
    v_mfma_f32_16x16x32_bf16 v[244:247], a[212:215], a[24:27], v[244:247]
    v_mfma_f32_16x16x32_bf16 v[244:247], a[216:219], a[28:31], v[244:247]
    v_mfma_f32_16x16x32_bf16 v[248:251], a[216:219], a[32:35], v[248:251]
    v_mfma_f32_16x16x32_bf16 v[248:251], a[212:215], a[28:31], v[248:251]
    v_mfma_f32_16x16x32_bf16 v[248:251], a[208:211], a[24:27], v[248:251]
    v_mfma_f32_16x16x32_bf16 v[252:255], a[208:211], a[28:31], v[252:255]
    v_mfma_f32_16x16x32_bf16 v[252:255], a[212:215], a[32:35], v[252:255]
    s_waitcnt lgkmcnt(0)
    v_mfma_f32_16x16x32_bf16 v[112:115], a[168:171], a[48:51], v[112:115]
    ds_read_b64_tr_b16 a[172:173], v17 offset:32
    v_mfma_f32_16x16x32_bf16 v[112:115], a[164:167], a[44:47], v[112:115]
    v_mfma_f32_16x16x32_bf16 v[112:115], a[160:163], a[40:43], v[112:115]
    ds_read_b64_tr_b16 a[174:175], v17 offset:2336
    v_mfma_f32_16x16x32_bf16 v[116:119], a[160:163], a[44:47], v[116:119]
    v_mfma_f32_16x16x32_bf16 v[116:119], a[164:167], a[48:51], v[116:119]
    v_mfma_f32_16x16x32_bf16 v[116:119], a[168:171], a[52:55], v[116:119]
    s_add_u32 m0, s43, 12288
    ds_read_b64_tr_b16 a[176:177], v17 offset:9248
    v_mfma_f32_16x16x32_bf16 v[120:123], a[168:171], a[56:59], v[120:123]
    buffer_load_dwordx4 v8, s[20:23], s41 offen offset:0 lds
    v_mfma_f32_16x16x32_bf16 v[120:123], a[164:167], a[52:55], v[120:123]
    v_mfma_f32_16x16x32_bf16 v[120:123], a[160:163], a[48:51], v[120:123]
    ds_read_b64_tr_b16 a[178:179], v17 offset:11552
    v_mfma_f32_16x16x32_bf16 v[124:127], a[160:163], a[52:55], v[124:127]
    v_mfma_f32_16x16x32_bf16 v[124:127], a[164:167], a[56:59], v[124:127]
    v_mfma_f32_16x16x32_bf16 v[124:127], a[168:171], a[60:63], v[124:127]
    ds_read_b64_tr_b16 a[180:181], v17 offset:18464
    v_mfma_f32_16x16x32_bf16 v[128:131], a[168:171], a[64:67], v[128:131]
    buffer_load_dwordx4 v9, s[20:23], s41 offen offset:1024 lds
    v_mfma_f32_16x16x32_bf16 v[128:131], a[164:167], a[60:63], v[128:131]
    v_mfma_f32_16x16x32_bf16 v[128:131], a[160:163], a[56:59], v[128:131]
    ds_read_b64_tr_b16 a[182:183], v17 offset:20768
    v_mfma_f32_16x16x32_bf16 v[132:135], a[160:163], a[60:63], v[132:135]
    v_mfma_f32_16x16x32_bf16 v[132:135], a[164:167], a[64:67], v[132:135]
    v_mfma_f32_16x16x32_bf16 v[132:135], a[168:171], a[68:71], v[132:135]
    v_mfma_f32_16x16x32_bf16 v[136:139], a[168:171], a[72:75], v[136:139]
    buffer_load_dwordx4 v10, s[20:23], s41 offen offset:2048 lds
    v_mfma_f32_16x16x32_bf16 v[136:139], a[164:167], a[68:71], v[136:139]
    v_mfma_f32_16x16x32_bf16 v[136:139], a[160:163], a[64:67], v[136:139]
    v_mfma_f32_16x16x32_bf16 v[140:143], a[160:163], a[68:71], v[140:143]
    v_mfma_f32_16x16x32_bf16 v[140:143], a[164:167], a[72:75], v[140:143]
    s_waitcnt lgkmcnt(0)
    v_mfma_f32_16x16x32_bf16 v[144:147], a[180:183], a[48:51], v[144:147]
    ds_read_b64_tr_b16 a[184:185], v17 offset:64
    v_mfma_f32_16x16x32_bf16 v[144:147], a[176:179], a[44:47], v[144:147]
    buffer_load_dwordx4 v11, s[20:23], s41 offen offset:3072 lds
    v_mfma_f32_16x16x32_bf16 v[144:147], a[172:175], a[40:43], v[144:147]
    v_mfma_f32_16x16x32_bf16 v[148:151], a[172:175], a[44:47], v[148:151]
    ds_read_b64_tr_b16 a[186:187], v17 offset:2368
    v_mfma_f32_16x16x32_bf16 v[148:151], a[176:179], a[48:51], v[148:151]
    v_mfma_f32_16x16x32_bf16 v[148:151], a[180:183], a[52:55], v[148:151]
    ds_read_b64_tr_b16 a[188:189], v17 offset:9280
    v_mfma_f32_16x16x32_bf16 v[152:155], a[180:183], a[56:59], v[152:155]
    s_add_u32 m0, s43, 28672
    v_mfma_f32_16x16x32_bf16 v[152:155], a[176:179], a[52:55], v[152:155]
    buffer_load_dwordx4 v12, s[20:23], s41 offen offset:0 lds
    v_mfma_f32_16x16x32_bf16 v[152:155], a[172:175], a[48:51], v[152:155]
    v_mfma_f32_16x16x32_bf16 v[156:159], a[172:175], a[52:55], v[156:159]
    ds_read_b64_tr_b16 a[190:191], v17 offset:11584
    v_mfma_f32_16x16x32_bf16 v[156:159], a[176:179], a[56:59], v[156:159]
    v_mfma_f32_16x16x32_bf16 v[156:159], a[180:183], a[60:63], v[156:159]
    ds_read_b64_tr_b16 a[192:193], v17 offset:18496
    v_mfma_f32_16x16x32_bf16 v[160:163], a[180:183], a[64:67], v[160:163]
    v_mfma_f32_16x16x32_bf16 v[160:163], a[176:179], a[60:63], v[160:163]
    buffer_load_dwordx4 v13, s[20:23], s41 offen offset:1024 lds
    v_mfma_f32_16x16x32_bf16 v[160:163], a[172:175], a[56:59], v[160:163]
    ds_read_b64_tr_b16 a[194:195], v17 offset:20800
    v_mfma_f32_16x16x32_bf16 v[164:167], a[172:175], a[60:63], v[164:167]
    v_mfma_f32_16x16x32_bf16 v[164:167], a[176:179], a[64:67], v[164:167]
    v_mfma_f32_16x16x32_bf16 v[164:167], a[180:183], a[68:71], v[164:167]
    v_mfma_f32_16x16x32_bf16 v[168:171], a[180:183], a[72:75], v[168:171]
    v_mfma_f32_16x16x32_bf16 v[168:171], a[176:179], a[68:71], v[168:171]
    buffer_load_dwordx4 v14, s[20:23], s41 offen offset:2048 lds
    v_mfma_f32_16x16x32_bf16 v[168:171], a[172:175], a[64:67], v[168:171]
    v_mfma_f32_16x16x32_bf16 v[172:175], a[172:175], a[68:71], v[172:175]
    v_mfma_f32_16x16x32_bf16 v[172:175], a[176:179], a[72:75], v[172:175]
    s_waitcnt lgkmcnt(0)
    v_mfma_f32_16x16x32_bf16 v[176:179], a[192:195], a[48:51], v[176:179]
    ds_read_b64_tr_b16 a[196:197], v17 offset:96
    v_mfma_f32_16x16x32_bf16 v[176:179], a[188:191], a[44:47], v[176:179]
    ds_read_b64_tr_b16 a[198:199], v17 offset:2400
    v_mfma_f32_16x16x32_bf16 v[176:179], a[184:187], a[40:43], v[176:179]
    buffer_load_dwordx4 v15, s[20:23], s41 offen offset:3072 lds
    v_mfma_f32_16x16x32_bf16 v[180:183], a[184:187], a[44:47], v[180:183]
    ds_read_b64_tr_b16 a[200:201], v17 offset:9312
    v_mfma_f32_16x16x32_bf16 v[180:183], a[188:191], a[48:51], v[180:183]
    ds_read_b64_tr_b16 a[202:203], v17 offset:11616
    v_mfma_f32_16x16x32_bf16 v[180:183], a[192:195], a[52:55], v[180:183]
    v_mfma_f32_16x16x32_bf16 v[184:187], a[192:195], a[56:59], v[184:187]
    ds_read_b64_tr_b16 a[204:205], v17 offset:18528
    v_mfma_f32_16x16x32_bf16 v[184:187], a[188:191], a[52:55], v[184:187]
    ds_read_b64_tr_b16 a[206:207], v17 offset:20832
    v_mfma_f32_16x16x32_bf16 v[184:187], a[184:187], a[48:51], v[184:187]
    ds_read_b64_tr_b16 a[208:209], v21 offset:0
    v_mfma_f32_16x16x32_bf16 v[188:191], a[184:187], a[52:55], v[188:191]
    ds_read_b64_tr_b16 a[210:211], v21 offset:2304
    v_mfma_f32_16x16x32_bf16 v[188:191], a[188:191], a[56:59], v[188:191]
    v_mfma_f32_16x16x32_bf16 v[188:191], a[192:195], a[60:63], v[188:191]
    ds_read_b64_tr_b16 a[212:213], v21 offset:9216
    v_mfma_f32_16x16x32_bf16 v[192:195], a[192:195], a[64:67], v[192:195]
    ds_read_b64_tr_b16 a[214:215], v21 offset:11520
    v_mfma_f32_16x16x32_bf16 v[192:195], a[188:191], a[60:63], v[192:195]
    ds_read_b64_tr_b16 a[216:217], v21 offset:18432
    v_mfma_f32_16x16x32_bf16 v[192:195], a[184:187], a[56:59], v[192:195]
    ds_read_b64_tr_b16 a[218:219], v21 offset:20736
    v_mfma_f32_16x16x32_bf16 v[196:199], a[184:187], a[60:63], v[196:199]
    v_mfma_f32_16x16x32_bf16 v[196:199], a[188:191], a[64:67], v[196:199]
    s_mov_b32 s45, s42
    s_add_u32 s42, s42, 27648
    v_mfma_f32_16x16x32_bf16 v[196:199], a[192:195], a[68:71], v[196:199]
    s_cmp_eq_u32 s42, 148480
    s_cselect_b32 s42, 65536, s42
    v_mfma_f32_16x16x32_bf16 v[200:203], a[192:195], a[72:75], v[200:203]
    s_add_u32 s40, s40, 36864
    v_add_u32 v17, s42, v16
    v_mfma_f32_16x16x32_bf16 v[200:203], a[188:191], a[68:71], v[200:203]
    v_add_u32 v21, s42, v20
    v_mfma_f32_16x16x32_bf16 v[200:203], a[184:187], a[64:67], v[200:203]
    v_mfma_f32_16x16x32_bf16 v[204:207], a[184:187], a[68:71], v[204:207]
    v_mfma_f32_16x16x32_bf16 v[204:207], a[188:191], a[72:75], v[204:207]
    s_waitcnt vmcnt(14) lgkmcnt(0)
    s_barrier
    v_mfma_f32_16x16x32_bf16 v[208:211], a[204:207], a[48:51], v[208:211]
    ds_read_b64_tr_b16 a[160:161], v17 offset:0
    v_mfma_f32_16x16x32_bf16 v[208:211], a[200:203], a[44:47], v[208:211]
    ds_read_b64_tr_b16 a[162:163], v17 offset:2304
    v_mfma_f32_16x16x32_bf16 v[208:211], a[196:199], a[40:43], v[208:211]
    ds_read_b64_tr_b16 a[164:165], v17 offset:9216
    v_mfma_f32_16x16x32_bf16 v[212:215], a[196:199], a[44:47], v[212:215]
    s_add_u32 m0, s45, 21504
    ds_read_b64_tr_b16 a[166:167], v17 offset:11520
    v_mfma_f32_16x16x32_bf16 v[212:215], a[200:203], a[48:51], v[212:215]
    buffer_load_dwordx4 v1, s[24:27], s40 offen offset:0 lds
    v_mfma_f32_16x16x32_bf16 v[212:215], a[204:207], a[52:55], v[212:215]
    v_mfma_f32_16x16x32_bf16 v[216:219], a[204:207], a[56:59], v[216:219]
    ds_read_b64_tr_b16 a[168:169], v17 offset:18432
    v_mfma_f32_16x16x32_bf16 v[216:219], a[200:203], a[52:55], v[216:219]
    ds_read_b64_tr_b16 a[170:171], v17 offset:20736
    v_mfma_f32_16x16x32_bf16 v[216:219], a[196:199], a[48:51], v[216:219]
    buffer_load_dwordx4 v2, s[24:27], s40 offen offset:1024 lds
    v_mfma_f32_16x16x32_bf16 v[220:223], a[196:199], a[52:55], v[220:223]
    ds_read_b128 a[0:3], v18 offset:7168
    v_mfma_f32_16x16x32_bf16 v[220:223], a[200:203], a[56:59], v[220:223]
    ds_read_b128 a[4:7], v18 offset:8192
    v_mfma_f32_16x16x32_bf16 v[220:223], a[204:207], a[60:63], v[220:223]
    v_mfma_f32_16x16x32_bf16 v[224:227], a[204:207], a[64:67], v[224:227]
    buffer_load_dwordx4 v3, s[24:27], s40 offen offset:2048 lds
    v_mfma_f32_16x16x32_bf16 v[224:227], a[200:203], a[60:63], v[224:227]
    ds_read_b128 a[8:11], v18 offset:9216
    v_mfma_f32_16x16x32_bf16 v[224:227], a[196:199], a[56:59], v[224:227]
    ds_read_b128 a[12:15], v18 offset:10240
    v_mfma_f32_16x16x32_bf16 v[228:231], a[196:199], a[60:63], v[228:231]
    ds_read_b128 a[16:19], v18 offset:11264
    v_mfma_f32_16x16x32_bf16 v[228:231], a[200:203], a[64:67], v[228:231]
    buffer_load_dwordx4 v4, s[24:27], s40 offen offset:3072 lds
    v_mfma_f32_16x16x32_bf16 v[228:231], a[204:207], a[68:71], v[228:231]
    ds_read_b128 a[20:23], v18 offset:12288
    v_mfma_f32_16x16x32_bf16 v[232:235], a[204:207], a[72:75], v[232:235]
    v_mfma_f32_16x16x32_bf16 v[232:235], a[200:203], a[68:71], v[232:235]
    s_add_u32 m0, s45, 25600
    ds_read_b128 a[24:27], v18 offset:13312
    v_mfma_f32_16x16x32_bf16 v[232:235], a[196:199], a[64:67], v[232:235]
    buffer_load_dwordx4 v5, s[24:27], s40 offen offset:0 lds
    v_mfma_f32_16x16x32_bf16 v[236:239], a[196:199], a[68:71], v[236:239]
    ds_read_b128 a[28:31], v18 offset:14336
    v_mfma_f32_16x16x32_bf16 v[236:239], a[200:203], a[72:75], v[236:239]
    ds_read_b128 a[32:35], v18 offset:15360
    v_mfma_f32_16x16x32_bf16 v[240:243], a[216:219], a[64:67], v[240:243]
    v_mfma_f32_16x16x32_bf16 v[240:243], a[212:215], a[60:63], v[240:243]
    buffer_load_dwordx4 v6, s[24:27], s40 offen offset:1024 lds
    v_mfma_f32_16x16x32_bf16 v[240:243], a[208:211], a[56:59], v[240:243]
    v_mfma_f32_16x16x32_bf16 v[244:247], a[208:211], a[60:63], v[244:247]
    v_mfma_f32_16x16x32_bf16 v[244:247], a[212:215], a[64:67], v[244:247]
    v_mfma_f32_16x16x32_bf16 v[244:247], a[216:219], a[68:71], v[244:247]
    v_mfma_f32_16x16x32_bf16 v[248:251], a[216:219], a[72:75], v[248:251]
    v_mfma_f32_16x16x32_bf16 v[248:251], a[212:215], a[68:71], v[248:251]
    v_mfma_f32_16x16x32_bf16 v[248:251], a[208:211], a[64:67], v[248:251]
    v_mfma_f32_16x16x32_bf16 v[252:255], a[208:211], a[68:71], v[252:255]
    s_add_u32 s44, s44, 1
    s_cmp_eq_u32 s44, 7
    v_mfma_f32_16x16x32_bf16 v[252:255], a[212:215], a[72:75], v[252:255]
    s_cbranch_scc0 L_loop3
    s_branch L_tail
.if (. - L_w3) > 4096
.error "variant page overflow"
.endif
.p2align 12
L_tail:
L_tp0:
    s_cbranch_vccnz L_back
    s_waitcnt lgkmcnt(0)
    v_mfma_f32_16x16x32_bf16 v[112:115], a[160:163], a[0:3], v[112:115]
    ds_read_b64_tr_b16 a[172:173], v17 offset:32
    v_add_u32 v29, 65536, v16
    v_mfma_f32_16x16x32_bf16 v[112:115], a[164:167], a[4:7], v[112:115]
    ds_read_b64_tr_b16 a[174:175], v17 offset:2336
    v_add_u32 v30, 65536, v20
    v_mfma_f32_16x16x32_bf16 v[112:115], a[168:171], a[8:11], v[112:115]
    ds_read_b64_tr_b16 a[176:177], v17 offset:9248
    v_mov_b32 v92, 150528
    v_mfma_f32_16x16x32_bf16 v[116:119], a[168:171], a[12:15], v[116:119]
    ds_read_b64_tr_b16 a[178:179], v17 offset:11552
    ds_read_b64_tr_b16 a[180:181], v17 offset:18464
    v_mfma_f32_16x16x32_bf16 v[116:119], a[164:167], a[8:11], v[116:119]
    ds_read_b64_tr_b16 a[182:183], v17 offset:20768
    v_mov_b32 v94, 0
    v_mfma_f32_16x16x32_bf16 v[116:119], a[160:163], a[4:7], v[116:119]
    ds_read_b64_tr_b16 a[208:209], v21 offset:0
    v_mov_b32 v95, 0
    v_mfma_f32_16x16x32_bf16 v[120:123], a[160:163], a[8:11], v[120:123]
    ds_read_b64_tr_b16 a[212:213], v21 offset:9216
    s_lshl_b32 s48, s53, 13
    v_mfma_f32_16x16x32_bf16 v[120:123], a[164:167], a[12:15], v[120:123]
    ds_read_b64_tr_b16 a[216:217], v21 offset:18432
    ds_read_b64_tr_b16 a[184:185], v17 offset:64
    v_mfma_f32_16x16x32_bf16 v[120:123], a[168:171], a[16:19], v[120:123]
    ds_read_b64_tr_b16 a[188:189], v17 offset:9280
    ds_write_b64 v92, v[94:95]
    v_mfma_f32_16x16x32_bf16 v[124:127], a[168:171], a[20:23], v[124:127]
    ds_read_b64_tr_b16 a[192:193], v17 offset:18496
    ds_write_b64 v92, v[94:95] offset:8
    v_mfma_f32_16x16x32_bf16 v[124:127], a[164:167], a[16:19], v[124:127]
    ds_read_b64_tr_b16 a[196:197], v17 offset:96
    s_cmp_eq_u32 s53, 1
    s_cselect_b64 s[46:47], -1, 0
    v_mfma_f32_16x16x32_bf16 v[124:127], a[160:163], a[12:15], v[124:127]
    ds_read_b64_tr_b16 a[200:201], v17 offset:9312
    ds_read_b64_tr_b16 a[204:205], v17 offset:18528
    v_mfma_f32_16x16x32_bf16 v[128:131], a[160:163], a[16:19], v[128:131]
    ds_read_b64_tr_b16 a[210:211], v21 offset:2304
    v_add_u32 v31, s48, v19
    v_mfma_f32_16x16x32_bf16 v[128:131], a[164:167], a[20:23], v[128:131]
    ds_read_b64_tr_b16 a[214:215], v21 offset:11520
    v_add_u32 v93, 7168, v19
    v_mfma_f32_16x16x32_bf16 v[128:131], a[168:171], a[24:27], v[128:131]
    ds_read_b64_tr_b16 a[218:219], v21 offset:20736
    v_cndmask_b32 v32, v92, v93, s[46:47]
    v_mfma_f32_16x16x32_bf16 v[132:135], a[168:171], a[28:31], v[132:135]
    ds_read_b64_tr_b16 a[186:187], v17 offset:2368
    ds_read_b64_tr_b16 a[190:191], v17 offset:11584
    v_mfma_f32_16x16x32_bf16 v[132:135], a[164:167], a[24:27], v[132:135]
    ds_read_b64_tr_b16 a[194:195], v17 offset:20800
    v_add_u32 v93, 8192, v19
    v_mfma_f32_16x16x32_bf16 v[132:135], a[160:163], a[20:23], v[132:135]
    ds_read_b64_tr_b16 a[198:199], v17 offset:2400
    v_cndmask_b32 v33, v93, v92, s[46:47]
    v_mfma_f32_16x16x32_bf16 v[136:139], a[160:163], a[24:27], v[136:139]
    ds_read_b64_tr_b16 a[202:203], v17 offset:11616
    v_xor_b32 v18, 32768, v18
    v_mfma_f32_16x16x32_bf16 v[136:139], a[164:167], a[28:31], v[136:139]
    ds_read_b64_tr_b16 a[206:207], v17 offset:20832
    v_add_u32 v34, s48, v18
    v_mfma_f32_16x16x32_bf16 v[136:139], a[168:171], a[32:35], v[136:139]
    ds_read_b128 a[40:43], v32
    v_add_u32 v93, 7168, v18
    v_mfma_f32_16x16x32_bf16 v[140:143], a[168:171], a[36:39], v[140:143]
    v_cndmask_b32 v35, v92, v93, s[46:47]
    v_add_u32 v93, 8192, v18
    v_mfma_f32_16x16x32_bf16 v[140:143], a[164:167], a[32:35], v[140:143]
    ds_read_b128 a[44:47], v31 offset:0
    v_cndmask_b32 v36, v93, v92, s[46:47]
    v_mfma_f32_16x16x32_bf16 v[140:143], a[160:163], a[28:31], v[140:143]
    ds_read_b128 a[48:51], v31 offset:1024
    v_xor_b32 v19, 32768, v19
    s_waitcnt vmcnt(0) lgkmcnt(3)
    s_barrier
    v_mfma_f32_16x16x32_bf16 v[144:147], a[172:175], a[0:3], v[144:147]
    s_add_u32 s40, s40, 36864
    s_add_u32 m0, s3, 120832
    s_nop 0
    buffer_load_dwordx4 v1, s[24:27], s40 offen offset:0 lds
    v_mfma_f32_16x16x32_bf16 v[144:147], a[176:179], a[4:7], v[144:147]
    ds_read_b64_tr_b16 a[220:221], v29 offset:0
    ds_read_b64_tr_b16 a[222:223], v29 offset:2304
    v_mfma_f32_16x16x32_bf16 v[144:147], a[180:183], a[8:11], v[144:147]
    buffer_load_dwordx4 v2, s[24:27], s40 offen offset:1024 lds
    v_mfma_f32_16x16x32_bf16 v[148:151], a[180:183], a[12:15], v[148:151]
    ds_read_b64_tr_b16 a[224:225], v29 offset:9216
    ds_read_b64_tr_b16 a[226:227], v29 offset:11520
    v_mfma_f32_16x16x32_bf16 v[148:151], a[176:179], a[8:11], v[148:151]
    buffer_load_dwordx4 v3, s[24:27], s40 offen offset:2048 lds
    v_mfma_f32_16x16x32_bf16 v[148:151], a[172:175], a[4:7], v[148:151]
    ds_read_b64_tr_b16 a[228:229], v29 offset:18432
    ds_read_b64_tr_b16 a[230:231], v29 offset:20736
    v_mfma_f32_16x16x32_bf16 v[152:155], a[172:175], a[8:11], v[152:155]
    buffer_load_dwordx4 v4, s[24:27], s40 offen offset:3072 lds
    v_mfma_f32_16x16x32_bf16 v[152:155], a[176:179], a[12:15], v[152:155]
    ds_read_b128 a[52:55], v31 offset:2048
    v_add_u32 v37, s48, v19
    v_mfma_f32_16x16x32_bf16 v[152:155], a[180:183], a[16:19], v[152:155]
    s_add_u32 m0, s3, 124928
    s_nop 0
    buffer_load_dwordx4 v5, s[24:27], s40 offen offset:0 lds
    v_mfma_f32_16x16x32_bf16 v[156:159], a[180:183], a[20:23], v[156:159]
    ds_read_b128 a[56:59], v31 offset:3072
    v_add_u32 v93, 7168, v19
    v_mfma_f32_16x16x32_bf16 v[156:159], a[176:179], a[16:19], v[156:159]
    buffer_load_dwordx4 v6, s[24:27], s40 offen offset:1024 lds
    v_mfma_f32_16x16x32_bf16 v[156:159], a[172:175], a[12:15], v[156:159]
    ds_read_b128 a[60:63], v31 offset:4096
    v_cndmask_b32 v38, v92, v93, s[46:47]
    v_mfma_f32_16x16x32_bf16 v[160:163], a[172:175], a[16:19], v[160:163]
    s_cmp_eq_u32 s36, 3
    s_cbranch_scc1 L_skw17
    buffer_load_dwordx4 v7, s[24:27], s40 offen offset:2048 lds
L_skw17:
    v_mfma_f32_16x16x32_bf16 v[160:163], a[176:179], a[20:23], v[160:163]
    ds_read_b128 a[64:67], v31 offset:5120
    v_add_u32 v93, 8192, v19
    v_mfma_f32_16x16x32_bf16 v[160:163], a[180:183], a[24:27], v[160:163]
    ds_read_b128 a[68:71], v31 offset:6144
    v_cndmask_b32 v39, v93, v92, s[46:47]
    v_mfma_f32_16x16x32_bf16 v[164:167], a[180:183], a[28:31], v[164:167]
    s_mov_b32 s50, 0x3fb8aa3b
    s_mov_b32 s51, 0x3fb8aa3b
    v_mfma_f32_16x16x32_bf16 v[164:167], a[176:179], a[24:27], v[164:167]
    ds_read_b128 a[72:75], v31 offset:7168
    v_lshlrev_b32 v24, 16, v24
    v_mfma_f32_16x16x32_bf16 v[164:167], a[172:175], a[20:23], v[164:167]
    ds_read_b128 a[76:79], v33
    v_lshlrev_b32 v25, 16, v25
    v_mfma_f32_16x16x32_bf16 v[168:171], a[172:175], a[24:27], v[168:171]
    ds_read_b64_tr_b16 a[160:161], v29 offset:32
    v_lshlrev_b32 v26, 16, v26
    v_mfma_f32_16x16x32_bf16 v[168:171], a[176:179], a[28:31], v[168:171]
    ds_read_b64_tr_b16 a[162:163], v29 offset:2336
    v_lshlrev_b32 v27, 16, v27
    v_mfma_f32_16x16x32_bf16 v[168:171], a[180:183], a[32:35], v[168:171]
    ds_read_b64_tr_b16 a[164:165], v29 offset:9248
    v_add_f32 v100, 0x3727c5ac, v25
    v_mfma_f32_16x16x32_bf16 v[172:175], a[180:183], a[36:39], v[172:175]
    ds_read_b64_tr_b16 a[166:167], v29 offset:11552
    ds_read_b64_tr_b16 a[168:169], v29 offset:18464
    v_mfma_f32_16x16x32_bf16 v[172:175], a[176:179], a[32:35], v[172:175]
    ds_read_b64_tr_b16 a[170:171], v29 offset:20768
    v_cvt_pk_bf16_f32 v100, v100, v100
    v_mfma_f32_16x16x32_bf16 v[172:175], a[172:175], a[28:31], v[172:175]
    ds_read_b64_tr_b16 a[232:233], v30 offset:27648
    v_lshlrev_b32 v100, 16, v100
    s_waitcnt lgkmcnt(12)
    v_mfma_f32_16x16x32_bf16 v[112:115], a[220:223], a[40:43], v[112:115]
    v_sqrt_f32 v100, v100
    s_nop 0
    v_mfma_f32_16x16x32_bf16 v[112:115], a[224:227], a[44:47], v[112:115]
    ds_read_b128 a[80:83], v35
    v_cvt_pk_bf16_f32 v100, v100, v100
    v_mfma_f32_16x16x32_bf16 v[112:115], a[228:231], a[48:51], v[112:115]
    ds_read_b128 a[96:99], v34 offset:3072
    v_lshlrev_b32 v100, 16, v100
    v_mfma_f32_16x16x32_bf16 v[116:119], a[228:231], a[52:55], v[116:119]
    ds_read_b64_tr_b16 a[234:235], v30 offset:29952
    v_rcp_f32 v100, v100
    s_nop 0
    v_mfma_f32_16x16x32_bf16 v[116:119], a[224:227], a[48:51], v[116:119]
    ds_read_b64_tr_b16 a[236:237], v30 offset:36864
    v_cvt_pk_bf16_f32 v100, v100, v100
    v_mfma_f32_16x16x32_bf16 v[116:119], a[220:223], a[44:47], v[116:119]
    ds_read_b128 a[84:87], v34 offset:0
    v_lshlrev_b32 v100, 16, v100
    v_mfma_f32_16x16x32_bf16 v[120:123], a[220:223], a[48:51], v[120:123]
    v_mul_f32 v100, v26, v100
    v_cvt_pk_bf16_f32 v100, v100, v100
    v_mfma_f32_16x16x32_bf16 v[120:123], a[224:227], a[52:55], v[120:123]
    ds_read_b128 a[100:103], v34 offset:4096
    v_lshlrev_b32 v100, 16, v100
    v_mfma_f32_16x16x32_bf16 v[120:123], a[228:231], a[56:59], v[120:123]
    ds_read_b64_tr_b16 a[238:239], v30 offset:39168
    v_fma_f32 v101, -v24, v100, v27
    s_waitcnt lgkmcnt(12)
    v_mfma_f32_16x16x32_bf16 v[124:127], a[228:231], a[60:63], v[124:127]
    ds_read_b64_tr_b16 a[240:241], v30 offset:46080
    v_mul_f32 v100, s50, v100
    v_mfma_f32_16x16x32_bf16 v[124:127], a[224:227], a[56:59], v[124:127]
    ds_read_b128 a[88:91], v34 offset:1024
    v_mul_f32 v101, s50, v101
    v_mfma_f32_16x16x32_bf16 v[124:127], a[220:223], a[52:55], v[124:127]
    v_add_u32 v28, 148480, v28
    ds_write_b32 v28, v100
    v_mfma_f32_16x16x32_bf16 v[128:131], a[220:223], a[56:59], v[128:131]
    ds_read_b128 a[104:107], v34 offset:5120
    ds_write_b32 v28, v101 offset:1024
    v_mfma_f32_16x16x32_bf16 v[128:131], a[224:227], a[60:63], v[128:131]
    ds_read_b64_tr_b16 a[242:243], v30 offset:48384
    s_lshl_b32 s47, s54, 7
    v_mfma_f32_16x16x32_bf16 v[128:131], a[228:231], a[64:67], v[128:131]
    ds_read_b128 a[120:123], v38
    v_lshrrev_b32 v92, 4, v0
    v_mfma_f32_16x16x32_bf16 v[132:135], a[228:231], a[68:71], v[132:135]
    v_lshlrev_b32 v92, 4, v92
    s_lshl_b32 s48, s47, 1
    v_mfma_f32_16x16x32_bf16 v[132:135], a[224:227], a[64:67], v[132:135]
    ds_read_b128 a[136:139], v37 offset:3072
    s_add_u32 s48, s48, 148480
    v_mfma_f32_16x16x32_bf16 v[132:135], a[220:223], a[60:63], v[132:135]
    ds_read_b128 a[124:127], v37 offset:0
    v_add_u32 v40, s48, v92
    v_mfma_f32_16x16x32_bf16 v[136:139], a[220:223], a[64:67], v[136:139]
    v_add_u32 v41, 148992, v92
    s_lshl_b32 s48, s36, 13
    v_mfma_f32_16x16x32_bf16 v[136:139], a[224:227], a[68:71], v[136:139]
    ds_read_b128 a[140:143], v37 offset:4096
    s_add_u32 s48, s48, 32768
    v_mfma_f32_16x16x32_bf16 v[136:139], a[228:231], a[72:75], v[136:139]
    v_and_b32 v92, 15, v0
    v_bfe_u32 v93, v0, 4, 1
    v_mfma_f32_16x16x32_bf16 v[140:143], a[228:231], a[76:79], v[140:143]
    ds_read_b128 a[128:131], v37 offset:1024
    v_lshrrev_b32 v94, 5, v0
    v_mfma_f32_16x16x32_bf16 v[140:143], a[224:227], a[72:75], v[140:143]
    ds_read_b64_tr_b16 a[228:229], v30 offset:18432
    ds_read_b64_tr_b16 a[230:231], v30 offset:20736
    v_mfma_f32_16x16x32_bf16 v[140:143], a[220:223], a[68:71], v[140:143]
    ds_read_b64_tr_b16 a[224:225], v30 offset:9216
    v_bfe_u32 v95, v0, 1, 2
    v_mfma_f32_16x16x32_bf16 v[144:147], a[160:163], a[40:43], v[144:147]
    ds_read_b64_tr_b16 a[220:221], v30 offset:0
    v_xor_b32 v95, v95, v94
    s_waitcnt lgkmcnt(12)
    v_mfma_f32_16x16x32_bf16 v[144:147], a[164:167], a[44:47], v[144:147]
    ds_read_b64_tr_b16 a[222:223], v30 offset:2304
    ds_read_b64_tr_b16 a[226:227], v30 offset:11520
    v_mfma_f32_16x16x32_bf16 v[144:147], a[168:171], a[48:51], v[144:147]
    v_lshlrev_b32 v96, 6, v92
    v_lshl_add_u32 v96, v95, 4, v96
    v_mfma_f32_16x16x32_bf16 v[148:151], a[168:171], a[52:55], v[148:151]
    ds_read_b128 a[144:147], v37 offset:5120
    v_lshl_add_u32 v96, v93, 3, v96
    v_mfma_f32_16x16x32_bf16 v[148:151], a[164:167], a[48:51], v[148:151]
    v_add_u32 v42, s48, v96
    v_xor_b32 v43, 32, v42
    v_mfma_f32_16x16x32_bf16 v[148:151], a[160:163], a[44:47], v[148:151]
    ds_read_b128 a[132:135], v37 offset:2048
    v_bfe_u32 v95, v0, 3, 2
    v_mfma_f32_16x16x32_bf16 v[152:155], a[160:163], a[48:51], v[152:155]
    ds_read_b128 a[148:151], v37 offset:6144
    v_xor_b32 v95, v95, v0
    v_mfma_f32_16x16x32_bf16 v[152:155], a[164:167], a[52:55], v[152:155]
    v_lshlrev_b32 v95, 4, v95
    v_add_u32 v45, s48, v95
    s_waitcnt vmcnt(0) lgkmcnt(12)
    s_barrier
    v_mfma_f32_16x16x32_bf16 v[152:155], a[168:171], a[56:59], v[152:155]
    ds_read_b64_tr_b16 a[244:245], v21 offset:0
    ds_read_b64_tr_b16 a[246:247], v21 offset:2304
    v_mfma_f32_16x16x32_bf16 v[156:159], a[168:171], a[60:63], v[156:159]
    ds_read_b64_tr_b16 a[248:249], v21 offset:9216
    ds_read_b64_tr_b16 a[250:251], v21 offset:11520
    v_mfma_f32_16x16x32_bf16 v[156:159], a[164:167], a[56:59], v[156:159]
    ds_read_b64_tr_b16 a[252:253], v21 offset:18432
    s_lshl_b32 s48, s36, 11
    v_mfma_f32_16x16x32_bf16 v[156:159], a[160:163], a[52:55], v[156:159]
    ds_read_b64_tr_b16 a[254:255], v21 offset:20736
    s_add_u32 s48, s48, 150592
    v_mfma_f32_16x16x32_bf16 v[160:163], a[160:163], a[56:59], v[160:163]
    v_lshlrev_b32 v96, 5, v92
    v_lshl_add_u32 v96, v94, 4, v96
    v_mfma_f32_16x16x32_bf16 v[160:163], a[164:167], a[60:63], v[160:163]
    ds_read_b128 a[92:95], v34 offset:2048
    v_lshl_add_u32 v96, v93, 3, v96
    v_mfma_f32_16x16x32_bf16 v[160:163], a[168:171], a[64:67], v[160:163]
    ds_read_b128 a[108:111], v34 offset:6144
    v_add_u32 v44, s48, v96
    v_mfma_f32_16x16x32_bf16 v[164:167], a[168:171], a[68:71], v[164:167]
    ds_read_b128 v[84:87], v41
    v_lshlrev_b32 v96, 4, v0
    v_mfma_f32_16x16x32_bf16 v[164:167], a[164:167], a[64:67], v[164:167]
    ds_read_b128 v[88:91], v41 offset:1024
    v_add_u32 v46, s48, v96
    v_mfma_f32_16x16x32_bf16 v[164:167], a[160:163], a[60:63], v[164:167]
    ds_read_b128 a[112:115], v34 offset:7168
    s_mul_i32 s48, s53, 9216
    v_mfma_f32_16x16x32_bf16 v[168:171], a[160:163], a[64:67], v[168:171]
    s_lshl_b32 s49, s38, 8
    s_add_u32 s48, s48, s49
    v_mfma_f32_16x16x32_bf16 v[168:171], a[164:167], a[68:71], v[168:171]
    ds_read_b128 a[152:155], v37 offset:7168
    s_add_u32 s49, s48, s47
    v_mfma_f32_16x16x32_bf16 v[168:171], a[168:171], a[72:75], v[168:171]
    v_lshrrev_b32 v92, 2, v0
    v_mul_u32_u24 v92, 18432, v92
    v_mfma_f32_16x16x32_bf16 v[172:175], a[168:171], a[76:79], v[172:175]
    ds_read_b128 a[156:159], v39
    v_and_b32 v93, 3, v0
    v_mfma_f32_16x16x32_bf16 v[172:175], a[164:167], a[72:75], v[172:175]
    ds_read_b128 a[116:119], v36
    v_lshl_add_u32 v92, v93, 4, v92
    v_mfma_f32_16x16x32_bf16 v[172:175], a[160:163], a[68:71], v[172:175]
    ds_read_b64_tr_b16 a[172:173], v29 offset:27648
    v_add_u32 v47, s49, v92
    s_waitcnt lgkmcnt(1)
    s_cmp_eq_u32 s54, 1
    s_cbranch_scc1 L_odd1
    v_mfma_f32_16x16x32_bf16 v[240:243], a[208:211], a[0:3], v[240:243]
    ds_read_b64_tr_b16 a[174:175], v29 offset:29952
    v_add_u32 v48, 4608, v47
    v_mfma_f32_16x16x32_bf16 v[240:243], a[212:215], a[4:7], v[240:243]
    ds_read_b64_tr_b16 a[176:177], v29 offset:36864
    ds_read_b64_tr_b16 a[178:179], v29 offset:39168
    v_mfma_f32_16x16x32_bf16 v[240:243], a[216:219], a[8:11], v[240:243]
    ds_read_b64_tr_b16 a[180:181], v29 offset:46080
    s_mul_i32 s49, s54, 4608
    v_mfma_f32_16x16x32_bf16 v[240:243], a[220:223], a[40:43], v[240:243]
    ds_read_b64_tr_b16 a[182:183], v29 offset:48384
    s_add_u32 s49, s49, s48
    v_mfma_f32_16x16x32_bf16 v[240:243], a[224:227], a[44:47], v[240:243]
    ds_read_b64_tr_b16 a[160:161], v17 offset:0
    s_add_u32 s49, s49, s52
    v_mfma_f32_16x16x32_bf16 v[240:243], a[228:231], a[48:51], v[240:243]
    ds_read_b64_tr_b16 a[162:163], v17 offset:2304
    ds_read_b64_tr_b16 a[164:165], v17 offset:9216
    v_mfma_f32_16x16x32_bf16 v[240:243], a[232:235], a[80:83], v[240:243]
    ds_read_b64_tr_b16 a[166:167], v17 offset:11520
    s_add_u32 s49, s49, 256
    v_mfma_f32_16x16x32_bf16 v[240:243], a[236:239], a[84:87], v[240:243]
    ds_read_b64_tr_b16 a[168:169], v17 offset:18432
    v_bfe_u32 v92, v0, 1, 4
    v_mfma_f32_16x16x32_bf16 v[240:243], a[240:243], a[88:91], v[240:243]
    ds_read_b64_tr_b16 a[170:171], v17 offset:20736
    v_mul_u32_u24 v92, 18432, v92
    v_mfma_f32_16x16x32_bf16 v[240:243], a[244:247], a[120:123], v[240:243]
    ds_read_b128 v[52:55], v40 offset:0
    ds_read_b128 v[56:59], v40 offset:1024
    v_mfma_f32_16x16x32_bf16 v[240:243], a[248:251], a[124:127], v[240:243]
    ds_read_b128 v[60:63], v40 offset:64
    v_mul_u32_u24 v93, 1152, v94
    v_mfma_f32_16x16x32_bf16 v[240:243], a[252:255], a[128:131], v[240:243]
    ds_read_b128 v[64:67], v40 offset:1088
    v_add3_u32 v92, v92, v93, s49
    v_mfma_f32_16x16x32_bf16 v[244:247], a[252:255], a[132:135], v[244:247]
    ds_read_b128 v[68:71], v40 offset:128
    v_and_b32 v93, 1, v0
    v_mfma_f32_16x16x32_bf16 v[244:247], a[248:251], a[128:131], v[244:247]
    ds_read_b128 v[72:75], v40 offset:1152
    ds_read_b128 v[76:79], v40 offset:192
    v_mfma_f32_16x16x32_bf16 v[244:247], a[244:247], a[124:127], v[244:247]
    ds_read_b128 v[80:83], v40 offset:1216
    v_lshl_add_u32 v49, v93, 4, v92
    v_mfma_f32_16x16x32_bf16 v[244:247], a[240:243], a[92:95], v[244:247]
    v_fma_f32 v240, v240, v84, v88
    v_fma_f32 v241, v241, v85, v89
    v_mfma_f32_16x16x32_bf16 v[244:247], a[236:239], a[88:91], v[244:247]
    v_fma_f32 v242, v242, v86, v90
    v_fma_f32 v243, v243, v87, v91
    v_mfma_f32_16x16x32_bf16 v[244:247], a[232:235], a[84:87], v[244:247]
    v_exp_f32 v92, -v240
    v_mfma_f32_16x16x32_bf16 v[244:247], a[228:231], a[52:55], v[244:247]
    v_exp_f32 v93, -v241
    v_mfma_f32_16x16x32_bf16 v[244:247], a[224:227], a[48:51], v[244:247]
    v_exp_f32 v94, -v242
    v_mfma_f32_16x16x32_bf16 v[244:247], a[220:223], a[44:47], v[244:247]
    v_exp_f32 v95, -v243
    v_mfma_f32_16x16x32_bf16 v[244:247], a[216:219], a[12:15], v[244:247]
    v_fma_f32 v92, v92, s50, s50
    v_fma_f32 v93, v93, s50, s50
    v_mfma_f32_16x16x32_bf16 v[244:247], a[212:215], a[8:11], v[244:247]
    v_fma_f32 v94, v94, s50, s50
    v_fma_f32 v95, v95, s50, s50
    v_mfma_f32_16x16x32_bf16 v[244:247], a[208:211], a[4:7], v[244:247]
    v_rcp_f32 v92, v92
    v_mfma_f32_16x16x32_bf16 v[248:251], a[208:211], a[8:11], v[248:251]
    v_rcp_f32 v93, v93
    v_mfma_f32_16x16x32_bf16 v[248:251], a[212:215], a[12:15], v[248:251]
    v_rcp_f32 v94, v94
    v_mfma_f32_16x16x32_bf16 v[248:251], a[216:219], a[16:19], v[248:251]
    v_rcp_f32 v95, v95
    v_mfma_f32_16x16x32_bf16 v[248:251], a[220:223], a[48:51], v[248:251]
    v_mul_f32 v240, v240, v92
    v_mul_f32 v241, v241, v93
    v_mfma_f32_16x16x32_bf16 v[248:251], a[224:227], a[52:55], v[248:251]
    v_mul_f32 v242, v242, v94
    v_mul_f32 v243, v243, v95
    v_mfma_f32_16x16x32_bf16 v[248:251], a[228:231], a[56:59], v[248:251]
    v_cvt_pk_bf16_f32 v24, v240, v241
    v_cvt_pk_bf16_f32 v25, v242, v243
    v_mfma_f32_16x16x32_bf16 v[248:251], a[232:235], a[88:91], v[248:251]
    ds_write_b64 v44, v[24:25] offset:0
    v_fma_f32 v244, v244, v84, v88
    v_fma_f32 v245, v245, v85, v89
    v_mfma_f32_16x16x32_bf16 v[248:251], a[236:239], a[92:95], v[248:251]
    v_fma_f32 v246, v246, v86, v90
    v_fma_f32 v247, v247, v87, v91
    v_mfma_f32_16x16x32_bf16 v[248:251], a[240:243], a[96:99], v[248:251]
    v_exp_f32 v96, -v244
    v_mfma_f32_16x16x32_bf16 v[248:251], a[244:247], a[128:131], v[248:251]
    v_exp_f32 v97, -v245
    v_mfma_f32_16x16x32_bf16 v[248:251], a[248:251], a[132:135], v[248:251]
    v_exp_f32 v98, -v246
    v_mfma_f32_16x16x32_bf16 v[248:251], a[252:255], a[136:139], v[248:251]
    v_exp_f32 v99, -v247
    v_mfma_f32_16x16x32_bf16 v[252:255], a[252:255], a[140:143], v[252:255]
    v_fma_f32 v96, v96, s50, s50
    v_fma_f32 v97, v97, s50, s50
    v_mfma_f32_16x16x32_bf16 v[252:255], a[248:251], a[136:139], v[252:255]
    ds_read_b64_tr_b16 a[252:253], v17 offset:18464
    v_fma_f32 v98, v98, s50, s50
    v_fma_f32 v99, v99, s50, s50
    v_mfma_f32_16x16x32_bf16 v[252:255], a[244:247], a[132:135], v[252:255]
    ds_read_b64_tr_b16 a[248:249], v17 offset:9248
    v_rcp_f32 v96, v96
    v_mfma_f32_16x16x32_bf16 v[252:255], a[240:243], a[100:103], v[252:255]
    ds_read_b64_tr_b16 a[244:245], v17 offset:32
    v_rcp_f32 v97, v97
    v_mfma_f32_16x16x32_bf16 v[252:255], a[236:239], a[96:99], v[252:255]
    ds_read_b64_tr_b16 a[240:241], v29 offset:46112
    v_rcp_f32 v98, v98
    v_mfma_f32_16x16x32_bf16 v[252:255], a[232:235], a[92:95], v[252:255]
    ds_read_b64_tr_b16 a[236:237], v29 offset:36896
    v_rcp_f32 v99, v99
    v_mfma_f32_16x16x32_bf16 v[252:255], a[228:231], a[60:63], v[252:255]
    ds_read_b64_tr_b16 a[232:233], v29 offset:27680
    v_fma_f32 v248, v248, v84, v88
    v_fma_f32 v249, v249, v85, v89
    v_mfma_f32_16x16x32_bf16 v[252:255], a[224:227], a[56:59], v[252:255]
    ds_read_b64_tr_b16 a[234:235], v29 offset:29984
    v_fma_f32 v250, v250, v86, v90
    v_fma_f32 v251, v251, v87, v91
    v_mfma_f32_16x16x32_bf16 v[252:255], a[220:223], a[52:55], v[252:255]
    ds_read_b64_tr_b16 a[238:239], v29 offset:39200
    v_exp_f32 v100, -v248
    v_mfma_f32_16x16x32_bf16 v[252:255], a[216:219], a[20:23], v[252:255]
    ds_read_b64_tr_b16 a[242:243], v29 offset:48416
    v_exp_f32 v101, -v249
    v_mfma_f32_16x16x32_bf16 v[252:255], a[212:215], a[16:19], v[252:255]
    ds_read_b64_tr_b16 a[246:247], v17 offset:2336
    v_exp_f32 v102, -v250
    v_mfma_f32_16x16x32_bf16 v[252:255], a[208:211], a[12:15], v[252:255]
    ds_read_b64_tr_b16 a[250:251], v17 offset:11552
    v_exp_f32 v103, -v251
    s_branch L_oddj
L_odd1:
    v_mfma_f32_16x16x32_bf16 v[240:243], a[208:211], a[16:19], v[240:243]
    ds_read_b64_tr_b16 a[174:175], v29 offset:29952
    v_add_u32 v48, 4608, v47
    v_mfma_f32_16x16x32_bf16 v[240:243], a[212:215], a[20:23], v[240:243]
    ds_read_b64_tr_b16 a[176:177], v29 offset:36864
    ds_read_b64_tr_b16 a[178:179], v29 offset:39168
    v_mfma_f32_16x16x32_bf16 v[240:243], a[216:219], a[24:27], v[240:243]
    ds_read_b64_tr_b16 a[180:181], v29 offset:46080
    s_mul_i32 s49, s54, 4608
    v_mfma_f32_16x16x32_bf16 v[240:243], a[220:223], a[56:59], v[240:243]
    ds_read_b64_tr_b16 a[182:183], v29 offset:48384
    s_add_u32 s49, s49, s48
    v_mfma_f32_16x16x32_bf16 v[240:243], a[224:227], a[60:63], v[240:243]
    ds_read_b64_tr_b16 a[160:161], v17 offset:0
    s_add_u32 s49, s49, s52
    v_mfma_f32_16x16x32_bf16 v[240:243], a[228:231], a[64:67], v[240:243]
    ds_read_b64_tr_b16 a[162:163], v17 offset:2304
    ds_read_b64_tr_b16 a[164:165], v17 offset:9216
    v_mfma_f32_16x16x32_bf16 v[240:243], a[232:235], a[96:99], v[240:243]
    ds_read_b64_tr_b16 a[166:167], v17 offset:11520
    s_add_u32 s49, s49, 256
    v_mfma_f32_16x16x32_bf16 v[240:243], a[236:239], a[100:103], v[240:243]
    ds_read_b64_tr_b16 a[168:169], v17 offset:18432
    v_bfe_u32 v92, v0, 1, 4
    v_mfma_f32_16x16x32_bf16 v[240:243], a[240:243], a[104:107], v[240:243]
    ds_read_b64_tr_b16 a[170:171], v17 offset:20736
    v_mul_u32_u24 v92, 18432, v92
    v_mfma_f32_16x16x32_bf16 v[240:243], a[244:247], a[136:139], v[240:243]
    ds_read_b128 v[52:55], v40 offset:0
    ds_read_b128 v[56:59], v40 offset:1024
    v_mfma_f32_16x16x32_bf16 v[240:243], a[248:251], a[140:143], v[240:243]
    ds_read_b128 v[60:63], v40 offset:64
    v_mul_u32_u24 v93, 1152, v94
    v_mfma_f32_16x16x32_bf16 v[240:243], a[252:255], a[144:147], v[240:243]
    ds_read_b128 v[64:67], v40 offset:1088
    v_add3_u32 v92, v92, v93, s49
    v_mfma_f32_16x16x32_bf16 v[244:247], a[252:255], a[148:151], v[244:247]
    ds_read_b128 v[68:71], v40 offset:128
    v_and_b32 v93, 1, v0
    v_mfma_f32_16x16x32_bf16 v[244:247], a[248:251], a[144:147], v[244:247]
    ds_read_b128 v[72:75], v40 offset:1152
    ds_read_b128 v[76:79], v40 offset:192
    v_mfma_f32_16x16x32_bf16 v[244:247], a[244:247], a[140:143], v[244:247]
    ds_read_b128 v[80:83], v40 offset:1216
    v_lshl_add_u32 v49, v93, 4, v92
    v_mfma_f32_16x16x32_bf16 v[244:247], a[240:243], a[108:111], v[244:247]
    v_fma_f32 v240, v240, v84, v88
    v_fma_f32 v241, v241, v85, v89
    v_mfma_f32_16x16x32_bf16 v[244:247], a[236:239], a[104:107], v[244:247]
    v_fma_f32 v242, v242, v86, v90
    v_fma_f32 v243, v243, v87, v91
    v_mfma_f32_16x16x32_bf16 v[244:247], a[232:235], a[100:103], v[244:247]
    v_exp_f32 v92, -v240
    v_mfma_f32_16x16x32_bf16 v[244:247], a[228:231], a[68:71], v[244:247]
    v_exp_f32 v93, -v241
    v_mfma_f32_16x16x32_bf16 v[244:247], a[224:227], a[64:67], v[244:247]
    v_exp_f32 v94, -v242
    v_mfma_f32_16x16x32_bf16 v[244:247], a[220:223], a[60:63], v[244:247]
    v_exp_f32 v95, -v243
    v_mfma_f32_16x16x32_bf16 v[244:247], a[216:219], a[28:31], v[244:247]
    v_fma_f32 v92, v92, s50, s50
    v_fma_f32 v93, v93, s50, s50
    v_mfma_f32_16x16x32_bf16 v[244:247], a[212:215], a[24:27], v[244:247]
    v_fma_f32 v94, v94, s50, s50
    v_fma_f32 v95, v95, s50, s50
    v_mfma_f32_16x16x32_bf16 v[244:247], a[208:211], a[20:23], v[244:247]
    v_rcp_f32 v92, v92
    v_mfma_f32_16x16x32_bf16 v[248:251], a[208:211], a[24:27], v[248:251]
    v_rcp_f32 v93, v93
    v_mfma_f32_16x16x32_bf16 v[248:251], a[212:215], a[28:31], v[248:251]
    v_rcp_f32 v94, v94
    v_mfma_f32_16x16x32_bf16 v[248:251], a[216:219], a[32:35], v[248:251]
    v_rcp_f32 v95, v95
    v_mfma_f32_16x16x32_bf16 v[248:251], a[220:223], a[64:67], v[248:251]
    v_mul_f32 v240, v240, v92
    v_mul_f32 v241, v241, v93
    v_mfma_f32_16x16x32_bf16 v[248:251], a[224:227], a[68:71], v[248:251]
    v_mul_f32 v242, v242, v94
    v_mul_f32 v243, v243, v95
    v_mfma_f32_16x16x32_bf16 v[248:251], a[228:231], a[72:75], v[248:251]
    v_cvt_pk_bf16_f32 v24, v240, v241
    v_cvt_pk_bf16_f32 v25, v242, v243
    v_mfma_f32_16x16x32_bf16 v[248:251], a[232:235], a[104:107], v[248:251]
    ds_write_b64 v44, v[24:25] offset:0
    v_fma_f32 v244, v244, v84, v88
    v_fma_f32 v245, v245, v85, v89
    v_mfma_f32_16x16x32_bf16 v[248:251], a[236:239], a[108:111], v[248:251]
    v_fma_f32 v246, v246, v86, v90
    v_fma_f32 v247, v247, v87, v91
    v_mfma_f32_16x16x32_bf16 v[248:251], a[240:243], a[112:115], v[248:251]
    v_exp_f32 v96, -v244
    v_mfma_f32_16x16x32_bf16 v[248:251], a[244:247], a[144:147], v[248:251]
    v_exp_f32 v97, -v245
    v_mfma_f32_16x16x32_bf16 v[248:251], a[248:251], a[148:151], v[248:251]
    v_exp_f32 v98, -v246
    v_mfma_f32_16x16x32_bf16 v[248:251], a[252:255], a[152:155], v[248:251]
    v_exp_f32 v99, -v247
    v_mfma_f32_16x16x32_bf16 v[252:255], a[252:255], a[156:159], v[252:255]
    v_fma_f32 v96, v96, s50, s50
    v_fma_f32 v97, v97, s50, s50
    v_mfma_f32_16x16x32_bf16 v[252:255], a[248:251], a[152:155], v[252:255]
    ds_read_b64_tr_b16 a[252:253], v17 offset:18464
    v_fma_f32 v98, v98, s50, s50
    v_fma_f32 v99, v99, s50, s50
    v_mfma_f32_16x16x32_bf16 v[252:255], a[244:247], a[148:151], v[252:255]
    ds_read_b64_tr_b16 a[248:249], v17 offset:9248
    v_rcp_f32 v96, v96
    v_mfma_f32_16x16x32_bf16 v[252:255], a[240:243], a[116:119], v[252:255]
    ds_read_b64_tr_b16 a[244:245], v17 offset:32
    v_rcp_f32 v97, v97
    v_mfma_f32_16x16x32_bf16 v[252:255], a[236:239], a[112:115], v[252:255]
    ds_read_b64_tr_b16 a[240:241], v29 offset:46112
    v_rcp_f32 v98, v98
    v_mfma_f32_16x16x32_bf16 v[252:255], a[232:235], a[108:111], v[252:255]
    ds_read_b64_tr_b16 a[236:237], v29 offset:36896
    v_rcp_f32 v99, v99
    v_mfma_f32_16x16x32_bf16 v[252:255], a[228:231], a[76:79], v[252:255]
    ds_read_b64_tr_b16 a[232:233], v29 offset:27680
    v_fma_f32 v248, v248, v84, v88
    v_fma_f32 v249, v249, v85, v89
    v_mfma_f32_16x16x32_bf16 v[252:255], a[224:227], a[72:75], v[252:255]
L_tp1:
    s_cbranch_vccnz L_back
    ds_read_b64_tr_b16 a[234:235], v29 offset:29984
    v_fma_f32 v250, v250, v86, v90
    v_fma_f32 v251, v251, v87, v91
    v_mfma_f32_16x16x32_bf16 v[252:255], a[220:223], a[68:71], v[252:255]
    ds_read_b64_tr_b16 a[238:239], v29 offset:39200
    v_exp_f32 v100, -v248
    v_mfma_f32_16x16x32_bf16 v[252:255], a[216:219], a[36:39], v[252:255]
    ds_read_b64_tr_b16 a[242:243], v29 offset:48416
    v_exp_f32 v101, -v249
    v_mfma_f32_16x16x32_bf16 v[252:255], a[212:215], a[32:35], v[252:255]
    ds_read_b64_tr_b16 a[246:247], v17 offset:2336
    v_exp_f32 v102, -v250
    v_mfma_f32_16x16x32_bf16 v[252:255], a[208:211], a[28:31], v[252:255]
    ds_read_b64_tr_b16 a[250:251], v17 offset:11552
    v_exp_f32 v103, -v251
L_oddj:
    s_waitcnt lgkmcnt(12)
    v_mfma_f32_16x16x32_bf16 v[112:115], a[172:175], a[80:83], v[112:115]
    ds_read_b64_tr_b16 a[254:255], v17 offset:20768
    v_mul_f32 v244, v244, v96
    v_mul_f32 v245, v245, v97
    v_mfma_f32_16x16x32_bf16 v[112:115], a[176:179], a[84:87], v[112:115]
    ds_read_b64_tr_b16 a[220:221], v29 offset:64
    v_mul_f32 v246, v246, v98
    v_mul_f32 v247, v247, v99
    v_mfma_f32_16x16x32_bf16 v[112:115], a[180:183], a[88:91], v[112:115]
    ds_read_b64_tr_b16 a[222:223], v29 offset:2368
    v_cvt_pk_bf16_f32 v26, v244, v245
    v_cvt_pk_bf16_f32 v27, v246, v247
    v_mfma_f32_16x16x32_bf16 v[112:115], a[160:163], a[120:123], v[112:115]
    ds_read_b64_tr_b16 a[224:225], v29 offset:9280
    v_fma_f32 v252, v252, v84, v88
    v_fma_f32 v253, v253, v85, v89
    v_mfma_f32_16x16x32_bf16 v[112:115], a[164:167], a[124:127], v[112:115]
    ds_read_b64_tr_b16 a[226:227], v29 offset:11584
    v_fma_f32 v254, v254, v86, v90
    v_fma_f32 v255, v255, v87, v91
    v_mfma_f32_16x16x32_bf16 v[112:115], a[168:171], a[128:131], v[112:115]
    ds_read_b64_tr_b16 a[228:229], v29 offset:18496
    v_fma_f32 v100, v100, s50, s50
    v_fma_f32 v101, v101, s50, s50
    v_mfma_f32_16x16x32_bf16 v[116:119], a[168:171], a[132:135], v[116:119]
    ds_read_b64_tr_b16 a[230:231], v29 offset:20800
    v_fma_f32 v102, v102, s50, s50
    v_fma_f32 v103, v103, s50, s50
    v_mfma_f32_16x16x32_bf16 v[116:119], a[164:167], a[128:131], v[116:119]
    ds_read_b64_tr_b16 a[208:209], v29 offset:96
    v_exp_f32 v92, -v252
    v_mfma_f32_16x16x32_bf16 v[116:119], a[160:163], a[124:127], v[116:119]
    ds_read_b64_tr_b16 a[210:211], v29 offset:2400
    v_exp_f32 v93, -v253
    v_mfma_f32_16x16x32_bf16 v[116:119], a[180:183], a[92:95], v[116:119]
    ds_read_b64_tr_b16 a[212:213], v29 offset:9312
    v_exp_f32 v94, -v254
    v_mfma_f32_16x16x32_bf16 v[116:119], a[176:179], a[88:91], v[116:119]
    ds_read_b64_tr_b16 a[214:215], v29 offset:11616
    v_exp_f32 v95, -v255
    v_mfma_f32_16x16x32_bf16 v[116:119], a[172:175], a[84:87], v[116:119]
    ds_read_b64_tr_b16 a[216:217], v29 offset:18528
    v_rcp_f32 v100, v100
    v_mfma_f32_16x16x32_bf16 v[120:123], a[172:175], a[88:91], v[120:123]
    ds_read_b64_tr_b16 a[218:219], v29 offset:20832
    v_rcp_f32 v101, v101
    v_mfma_f32_16x16x32_bf16 v[120:123], a[176:179], a[92:95], v[120:123]
    ds_write_b64 v44, v[26:27] offset:512
    v_rcp_f32 v102, v102
    v_mfma_f32_16x16x32_bf16 v[120:123], a[180:183], a[96:99], v[120:123]
    ds_read_b128 v[244:247], v46 offset:0
    v_rcp_f32 v103, v103
    v_mfma_f32_16x16x32_bf16 v[120:123], a[160:163], a[128:131], v[120:123]
    v_fma_f32 v112, v112, v52, v56
    v_fma_f32 v113, v113, v53, v57
    v_mfma_f32_16x16x32_bf16 v[120:123], a[164:167], a[132:135], v[120:123]
    v_fma_f32 v114, v114, v54, v58
    v_fma_f32 v115, v115, v55, v59
    v_mfma_f32_16x16x32_bf16 v[120:123], a[168:171], a[136:139], v[120:123]
    v_fma_f32 v92, v92, s50, s50
    v_fma_f32 v93, v93, s50, s50
    v_mfma_f32_16x16x32_bf16 v[124:127], a[168:171], a[140:143], v[124:127]
    v_fma_f32 v94, v94, s50, s50
    v_fma_f32 v95, v95, s50, s50
    v_mfma_f32_16x16x32_bf16 v[124:127], a[164:167], a[136:139], v[124:127]
    v_exp_f32 v96, -v112
    v_mfma_f32_16x16x32_bf16 v[124:127], a[160:163], a[132:135], v[124:127]
    v_exp_f32 v97, -v113
    v_mfma_f32_16x16x32_bf16 v[124:127], a[180:183], a[100:103], v[124:127]
    v_exp_f32 v98, -v114
    v_mfma_f32_16x16x32_bf16 v[124:127], a[176:179], a[96:99], v[124:127]
    s_waitcnt lgkmcnt(0)
    v_exp_f32 v99, -v115
    v_mfma_f32_16x16x32_bf16 v[124:127], a[172:175], a[92:95], v[124:127]
    buffer_store_dwordx4 v[244:247], v49, s[28:31], 0 offen offset:0
    v_mul_f32 v248, v248, v100
    v_mul_f32 v249, v249, v101
    v_mfma_f32_16x16x32_bf16 v[128:131], a[172:175], a[96:99], v[128:131]
    v_mul_f32 v250, v250, v102
    v_mul_f32 v251, v251, v103
    v_mfma_f32_16x16x32_bf16 v[128:131], a[176:179], a[100:103], v[128:131]
    v_cvt_pk_bf16_f32 v104, v248, v249
    v_cvt_pk_bf16_f32 v105, v250, v251
    v_mfma_f32_16x16x32_bf16 v[128:131], a[180:183], a[104:107], v[128:131]
    ds_write_b64 v44, v[104:105] offset:1024
    v_rcp_f32 v92, v92
    v_mfma_f32_16x16x32_bf16 v[128:131], a[160:163], a[136:139], v[128:131]
    v_rcp_f32 v93, v93
    v_mfma_f32_16x16x32_bf16 v[128:131], a[164:167], a[140:143], v[128:131]
    v_rcp_f32 v94, v94
    v_mfma_f32_16x16x32_bf16 v[128:131], a[168:171], a[144:147], v[128:131]
    v_rcp_f32 v95, v95
    v_mfma_f32_16x16x32_bf16 v[132:135], a[168:171], a[148:151], v[132:135]
    v_fma_f32 v116, v116, v52, v56
    v_fma_f32 v117, v117, v53, v57
    v_mfma_f32_16x16x32_bf16 v[132:135], a[164:167], a[144:147], v[132:135]
    v_fma_f32 v118, v118, v54, v58
    v_fma_f32 v119, v119, v55, v59
    v_mfma_f32_16x16x32_bf16 v[132:135], a[160:163], a[140:143], v[132:135]
    v_fma_f32 v96, v96, s50, s50
    v_fma_f32 v97, v97, s50, s50
    v_mfma_f32_16x16x32_bf16 v[132:135], a[180:183], a[108:111], v[132:135]
    v_fma_f32 v98, v98, s50, s50
    v_fma_f32 v99, v99, s50, s50
    v_mfma_f32_16x16x32_bf16 v[132:135], a[176:179], a[104:107], v[132:135]
    v_exp_f32 v100, -v116
    v_mfma_f32_16x16x32_bf16 v[132:135], a[172:175], a[100:103], v[132:135]
    v_exp_f32 v101, -v117
    v_mfma_f32_16x16x32_bf16 v[136:139], a[172:175], a[104:107], v[136:139]
    v_exp_f32 v102, -v118
    v_mfma_f32_16x16x32_bf16 v[136:139], a[176:179], a[108:111], v[136:139]
    v_exp_f32 v103, -v119
    v_mfma_f32_16x16x32_bf16 v[136:139], a[180:183], a[112:115], v[136:139]
    v_mul_f32 v252, v252, v92
    v_mul_f32 v253, v253, v93
    v_mfma_f32_16x16x32_bf16 v[136:139], a[160:163], a[144:147], v[136:139]
    v_mul_f32 v254, v254, v94
    v_mul_f32 v255, v255, v95
    v_mfma_f32_16x16x32_bf16 v[136:139], a[164:167], a[148:151], v[136:139]
    v_cvt_pk_bf16_f32 v106, v252, v253
    v_cvt_pk_bf16_f32 v107, v254, v255
    v_mfma_f32_16x16x32_bf16 v[136:139], a[168:171], a[152:155], v[136:139]
    ds_write_b64 v44, v[106:107] offset:1536
    v_rcp_f32 v96, v96
    v_mfma_f32_16x16x32_bf16 v[140:143], a[168:171], a[156:159], v[140:143]
    ds_read_b128 v[252:255], v46 offset:1024
    v_rcp_f32 v97, v97
    v_mfma_f32_16x16x32_bf16 v[140:143], a[164:167], a[152:155], v[140:143]
    ds_read_b64_tr_b16 a[168:169], v29 offset:46144
    v_rcp_f32 v98, v98
    v_mfma_f32_16x16x32_bf16 v[140:143], a[160:163], a[148:151], v[140:143]
    ds_read_b64_tr_b16 a[164:165], v29 offset:36928
    v_rcp_f32 v99, v99
    v_mfma_f32_16x16x32_bf16 v[140:143], a[180:183], a[116:119], v[140:143]
    ds_read_b64_tr_b16 a[160:161], v29 offset:27712
    v_fma_f32 v120, v120, v52, v56
    v_fma_f32 v121, v121, v53, v57
    v_mfma_f32_16x16x32_bf16 v[140:143], a[176:179], a[112:115], v[140:143]
    ds_read_b64_tr_b16 a[162:163], v29 offset:30016
    v_fma_f32 v122, v122, v54, v58
    v_fma_f32 v123, v123, v55, v59
    v_mfma_f32_16x16x32_bf16 v[140:143], a[172:175], a[108:111], v[140:143]
    ds_read_b64_tr_b16 a[166:167], v29 offset:39232
    v_fma_f32 v100, v100, s50, s50
    v_fma_f32 v101, v101, s50, s50
    v_mfma_f32_16x16x32_bf16 v[144:147], a[232:235], a[80:83], v[144:147]
    ds_read_b64_tr_b16 a[170:171], v29 offset:48448
    v_fma_f32 v102, v102, s50, s50
    v_fma_f32 v103, v103, s50, s50
    v_mfma_f32_16x16x32_bf16 v[144:147], a[236:239], a[84:87], v[144:147]
    ds_read_b64_tr_b16 a[172:173], v17 offset:64
    v_exp_f32 v92, -v120
    v_mfma_f32_16x16x32_bf16 v[144:147], a[240:243], a[88:91], v[144:147]
    ds_read_b64_tr_b16 a[174:175], v17 offset:2368
    v_exp_f32 v93, -v121
    v_mfma_f32_16x16x32_bf16 v[144:147], a[244:247], a[120:123], v[144:147]
    ds_read_b64_tr_b16 a[176:177], v17 offset:9280
    v_exp_f32 v94, -v122
    v_mfma_f32_16x16x32_bf16 v[144:147], a[248:251], a[124:127], v[144:147]
    ds_read_b64_tr_b16 a[178:179], v17 offset:11584
    v_exp_f32 v95, -v123
    v_mfma_f32_16x16x32_bf16 v[144:147], a[252:255], a[128:131], v[144:147]
    ds_read_b64_tr_b16 a[180:181], v17 offset:18496
    v_mul_f32 v112, v112, v96
    v_mul_f32 v113, v113, v97
    v_mfma_f32_16x16x32_bf16 v[148:151], a[252:255], a[132:135], v[148:151]
    ds_read_b64_tr_b16 a[182:183], v17 offset:20800
    v_mul_f32 v114, v114, v98
    v_mul_f32 v115, v115, v99
    v_mfma_f32_16x16x32_bf16 v[148:151], a[248:251], a[128:131], v[148:151]
    s_waitcnt lgkmcnt(12)
    v_cvt_pk_bf16_f32 v24, v112, v113
    v_cvt_pk_bf16_f32 v25, v114, v115
    v_mfma_f32_16x16x32_bf16 v[148:151], a[244:247], a[124:127], v[148:151]
    ds_write_b64 v42, v[24:25] offset:0
    v_rcp_f32 v100, v100
    v_mfma_f32_16x16x32_bf16 v[148:151], a[240:243], a[92:95], v[148:151]
    buffer_store_dwordx4 v[252:255], v49, s[28:31], 0 offen offset:2304
    v_rcp_f32 v101, v101
    v_mfma_f32_16x16x32_bf16 v[148:151], a[236:239], a[88:91], v[148:151]
    v_rcp_f32 v102, v102
    v_mfma_f32_16x16x32_bf16 v[148:151], a[232:235], a[84:87], v[148:151]
    v_rcp_f32 v103, v103
    v_mfma_f32_16x16x32_bf16 v[152:155], a[232:235], a[88:91], v[152:155]
    v_fma_f32 v144, v144, v60, v64
    v_fma_f32 v145, v145, v61, v65
    v_mfma_f32_16x16x32_bf16 v[152:155], a[236:239], a[92:95], v[152:155]
    v_fma_f32 v146, v146, v62, v66
    v_fma_f32 v147, v147, v63, v67
    v_mfma_f32_16x16x32_bf16 v[152:155], a[240:243], a[96:99], v[152:155]
    v_fma_f32 v92, v92, s50, s50
    v_fma_f32 v93, v93, s50, s50
    v_mfma_f32_16x16x32_bf16 v[152:155], a[244:247], a[128:131], v[152:155]
    v_fma_f32 v94, v94, s50, s50
    v_fma_f32 v95, v95, s50, s50
    v_mfma_f32_16x16x32_bf16 v[152:155], a[248:251], a[132:135], v[152:155]
    v_exp_f32 v96, -v144
    v_mfma_f32_16x16x32_bf16 v[152:155], a[252:255], a[136:139], v[152:155]
    v_exp_f32 v97, -v145
    v_mfma_f32_16x16x32_bf16 v[156:159], a[252:255], a[140:143], v[156:159]
    v_exp_f32 v98, -v146
    v_mfma_f32_16x16x32_bf16 v[156:159], a[248:251], a[136:139], v[156:159]
    v_exp_f32 v99, -v147
    v_mfma_f32_16x16x32_bf16 v[156:159], a[244:247], a[132:135], v[156:159]
    v_mul_f32 v116, v116, v100
    v_mul_f32 v117, v117, v101
    v_mfma_f32_16x16x32_bf16 v[156:159], a[240:243], a[100:103], v[156:159]
    v_mul_f32 v118, v118, v102
    v_mul_f32 v119, v119, v103
    v_mfma_f32_16x16x32_bf16 v[156:159], a[236:239], a[96:99], v[156:159]
    v_cvt_pk_bf16_f32 v26, v116, v117
    v_cvt_pk_bf16_f32 v27, v118, v119
    v_mfma_f32_16x16x32_bf16 v[156:159], a[232:235], a[92:95], v[156:159]
    ds_write_b64 v42, v[26:27] offset:1024
    v_rcp_f32 v92, v92
    v_mfma_f32_16x16x32_bf16 v[160:163], a[232:235], a[96:99], v[160:163]
    v_rcp_f32 v93, v93
    v_mfma_f32_16x16x32_bf16 v[160:163], a[236:239], a[100:103], v[160:163]
    v_rcp_f32 v94, v94
    v_mfma_f32_16x16x32_bf16 v[160:163], a[240:243], a[104:107], v[160:163]
    v_rcp_f32 v95, v95
    v_mfma_f32_16x16x32_bf16 v[160:163], a[244:247], a[136:139], v[160:163]
    v_fma_f32 v148, v148, v60, v64
    v_fma_f32 v149, v149, v61, v65
    v_mfma_f32_16x16x32_bf16 v[160:163], a[248:251], a[140:143], v[160:163]
    v_fma_f32 v150, v150, v62, v66
    v_fma_f32 v151, v151, v63, v67
    v_mfma_f32_16x16x32_bf16 v[160:163], a[252:255], a[144:147], v[160:163]
    v_fma_f32 v96, v96, s50, s50
    v_fma_f32 v97, v97, s50, s50
    v_mfma_f32_16x16x32_bf16 v[164:167], a[252:255], a[148:151], v[164:167]
    v_fma_f32 v98, v98, s50, s50
    v_fma_f32 v99, v99, s50, s50
    v_mfma_f32_16x16x32_bf16 v[164:167], a[248:251], a[144:147], v[164:167]
    v_exp_f32 v100, -v148
    v_mfma_f32_16x16x32_bf16 v[164:167], a[244:247], a[140:143], v[164:167]
    v_exp_f32 v101, -v149
    v_mfma_f32_16x16x32_bf16 v[164:167], a[240:243], a[108:111], v[164:167]
    v_exp_f32 v102, -v150
    v_mfma_f32_16x16x32_bf16 v[164:167], a[236:239], a[104:107], v[164:167]
    v_exp_f32 v103, -v151
    v_mfma_f32_16x16x32_bf16 v[164:167], a[232:235], a[100:103], v[164:167]
    v_mul_f32 v120, v120, v92
    v_mul_f32 v121, v121, v93
    v_mfma_f32_16x16x32_bf16 v[168:171], a[232:235], a[104:107], v[168:171]
    v_mul_f32 v122, v122, v94
    v_mul_f32 v123, v123, v95
    v_mfma_f32_16x16x32_bf16 v[168:171], a[236:239], a[108:111], v[168:171]
    v_cvt_pk_bf16_f32 v104, v120, v121
    v_cvt_pk_bf16_f32 v105, v122, v123
    v_mfma_f32_16x16x32_bf16 v[168:171], a[240:243], a[112:115], v[168:171]
    ds_write_b64 v42, v[104:105] offset:2048
    v_rcp_f32 v96, v96
    v_mfma_f32_16x16x32_bf16 v[168:171], a[244:247], a[144:147], v[168:171]
    v_rcp_f32 v97, v97
    v_mfma_f32_16x16x32_bf16 v[168:171], a[248:251], a[148:151], v[168:171]
    v_rcp_f32 v98, v98
    v_mfma_f32_16x16x32_bf16 v[168:171], a[252:255], a[152:155], v[168:171]
    v_rcp_f32 v99, v99
    v_mfma_f32_16x16x32_bf16 v[172:175], a[252:255], a[156:159], v[172:175]
    v_fma_f32 v152, v152, v60, v64
    v_fma_f32 v153, v153, v61, v65
    v_mfma_f32_16x16x32_bf16 v[172:175], a[248:251], a[152:155], v[172:175]
    ds_read_b64_tr_b16 a[252:253], v17 offset:18528
    v_fma_f32 v154, v154, v62, v66
    v_fma_f32 v155, v155, v63, v67
    v_mfma_f32_16x16x32_bf16 v[172:175], a[244:247], a[148:151], v[172:175]
    ds_read_b64_tr_b16 a[248:249], v17 offset:9312
    v_fma_f32 v100, v100, s50, s50
    v_fma_f32 v101, v101, s50, s50
    v_mfma_f32_16x16x32_bf16 v[172:175], a[240:243], a[116:119], v[172:175]
    ds_read_b64_tr_b16 a[244:245], v17 offset:96
    v_fma_f32 v102, v102, s50, s50
    v_fma_f32 v103, v103, s50, s50
    v_mfma_f32_16x16x32_bf16 v[172:175], a[236:239], a[112:115], v[172:175]
    ds_read_b64_tr_b16 a[240:241], v29 offset:46176
    v_exp_f32 v92, -v152
    v_mfma_f32_16x16x32_bf16 v[172:175], a[232:235], a[108:111], v[172:175]
    ds_read_b64_tr_b16 a[236:237], v29 offset:36960
    v_exp_f32 v93, -v153
    v_mfma_f32_16x16x32_bf16 v[176:179], a[184:187], a[0:3], v[176:179]
    ds_read_b64_tr_b16 a[232:233], v29 offset:27744
    v_exp_f32 v94, -v154
    v_mfma_f32_16x16x32_bf16 v[176:179], a[188:191], a[4:7], v[176:179]
    ds_read_b64_tr_b16 a[234:235], v29 offset:30048
    v_exp_f32 v95, -v155
    v_mfma_f32_16x16x32_bf16 v[176:179], a[192:195], a[8:11], v[176:179]
    ds_read_b64_tr_b16 a[238:239], v29 offset:39264
    v_mul_f32 v144, v144, v96
    v_mul_f32 v145, v145, v97
    v_mfma_f32_16x16x32_bf16 v[176:179], a[220:223], a[40:43], v[176:179]
    ds_read_b64_tr_b16 a[242:243], v29 offset:48480
    v_mul_f32 v146, v146, v98
    v_mul_f32 v147, v147, v99
    v_mfma_f32_16x16x32_bf16 v[176:179], a[224:227], a[44:47], v[176:179]
    ds_read_b64_tr_b16 a[246:247], v17 offset:2400
    v_cvt_pk_bf16_f32 v106, v144, v145
    v_cvt_pk_bf16_f32 v107, v146, v147
    v_mfma_f32_16x16x32_bf16 v[176:179], a[228:231], a[48:51], v[176:179]
    ds_read_b64_tr_b16 a[250:251], v17 offset:11616
    v_rcp_f32 v100, v100
    v_mfma_f32_16x16x32_bf16 v[180:183], a[228:231], a[52:55], v[180:183]
    ds_read_b64_tr_b16 a[254:255], v17 offset:20832
    v_rcp_f32 v101, v101
    v_mfma_f32_16x16x32_bf16 v[180:183], a[224:227], a[48:51], v[180:183]
    ds_write_b64 v43, v[106:107] offset:0
    v_rcp_f32 v102, v102
    v_mfma_f32_16x16x32_bf16 v[180:183], a[220:223], a[44:47], v[180:183]
    ds_read_b128 v[144:147], v45 offset:0
    v_rcp_f32 v103, v103
    v_mfma_f32_16x16x32_bf16 v[180:183], a[192:195], a[12:15], v[180:183]
    v_fma_f32 v124, v124, v52, v56
    v_fma_f32 v125, v125, v53, v57
    v_mfma_f32_16x16x32_bf16 v[180:183], a[188:191], a[8:11], v[180:183]
    v_fma_f32 v126, v126, v54, v58
    v_fma_f32 v127, v127, v55, v59
    v_mfma_f32_16x16x32_bf16 v[180:183], a[184:187], a[4:7], v[180:183]
    v_fma_f32 v92, v92, s50, s50
    v_fma_f32 v93, v93, s50, s50
    v_mfma_f32_16x16x32_bf16 v[184:187], a[184:187], a[8:11], v[184:187]
    v_fma_f32 v94, v94, s50, s50
    v_fma_f32 v95, v95, s50, s50
    v_mfma_f32_16x16x32_bf16 v[184:187], a[188:191], a[12:15], v[184:187]
    v_exp_f32 v96, -v124
    v_mfma_f32_16x16x32_bf16 v[184:187], a[192:195], a[16:19], v[184:187]
    v_exp_f32 v97, -v125
    v_mfma_f32_16x16x32_bf16 v[184:187], a[220:223], a[48:51], v[184:187]
    v_exp_f32 v98, -v126
    v_mfma_f32_16x16x32_bf16 v[184:187], a[224:227], a[52:55], v[184:187]
    s_waitcnt lgkmcnt(0)
    v_exp_f32 v99, -v127
    v_mfma_f32_16x16x32_bf16 v[184:187], a[228:231], a[56:59], v[184:187]
    buffer_store_dwordx4 v[144:147], v47, s[28:31], 0 offen offset:0 nt sc1
    v_mul_f32 v148, v148, v100
    v_mul_f32 v149, v149, v101
    v_mfma_f32_16x16x32_bf16 v[188:191], a[228:231], a[60:63], v[188:191]
    v_mul_f32 v150, v150, v102
    v_mul_f32 v151, v151, v103
    v_mfma_f32_16x16x32_bf16 v[188:191], a[224:227], a[56:59], v[188:191]
    v_cvt_pk_bf16_f32 v24, v148, v149
    v_cvt_pk_bf16_f32 v25, v150, v151
    v_mfma_f32_16x16x32_bf16 v[188:191], a[220:223], a[52:55], v[188:191]
    ds_write_b64 v43, v[24:25] offset:1024
    v_rcp_f32 v92, v92
    v_mfma_f32_16x16x32_bf16 v[188:191], a[192:195], a[20:23], v[188:191]
    v_rcp_f32 v93, v93
    v_mfma_f32_16x16x32_bf16 v[188:191], a[188:191], a[16:19], v[188:191]
    v_rcp_f32 v94, v94
    v_rcp_f32 v95, v95
    v_pk_fma_f32 v[156:157], v[156:157], v[60:61], v[64:65]
    v_pk_fma_f32 v[158:159], v[158:159], v[62:63], v[66:67]
    v_pk_fma_f32 v[96:97], v[96:97], s[50:51], s[50:51]
    v_pk_fma_f32 v[98:99], v[98:99], s[50:51], s[50:51]
    v_pk_mul_f32 v[152:153], v[152:153], v[92:93]
    v_pk_mul_f32 v[154:155], v[154:155], v[94:95]
    v_mfma_f32_16x16x32_bf16 v[188:191], a[184:187], a[12:15], v[188:191]
    v_exp_f32 v100, -v156
    v_mfma_f32_16x16x32_bf16 v[192:195], a[184:187], a[16:19], v[192:195]
    v_exp_f32 v101, -v157
    v_mfma_f32_16x16x32_bf16 v[192:195], a[188:191], a[20:23], v[192:195]
    v_exp_f32 v102, -v158
    v_mfma_f32_16x16x32_bf16 v[192:195], a[192:195], a[24:27], v[192:195]
    ds_read_b128 v[148:151], v45 offset:1024
    v_mfma_f32_16x16x32_bf16 v[192:195], a[220:223], a[56:59], v[192:195]
    v_exp_f32 v103, -v159
    v_mfma_f32_16x16x32_bf16 v[192:195], a[224:227], a[60:63], v[192:195]
    v_rcp_f32 v96, v96
    v_mfma_f32_16x16x32_bf16 v[192:195], a[228:231], a[64:67], v[192:195]
    v_rcp_f32 v97, v97
    v_mfma_f32_16x16x32_bf16 v[196:199], a[228:231], a[68:71], v[196:199]
    v_rcp_f32 v98, v98
    v_rcp_f32 v99, v99
    v_cvt_pk_bf16_f32 v26, v152, v153
    v_cvt_pk_bf16_f32 v27, v154, v155
    v_pk_fma_f32 v[128:129], v[128:129], v[52:53], v[56:57]
    v_pk_fma_f32 v[130:131], v[130:131], v[54:55], v[58:59]
    v_pk_fma_f32 v[100:101], v[100:101], s[50:51], s[50:51]
    v_pk_fma_f32 v[102:103], v[102:103], s[50:51], s[50:51]
    v_pk_mul_f32 v[124:125], v[124:125], v[96:97]
    v_pk_mul_f32 v[126:127], v[126:127], v[98:99]
    v_mfma_f32_16x16x32_bf16 v[196:199], a[224:227], a[64:67], v[196:199]
    v_exp_f32 v92, -v128
    v_mfma_f32_16x16x32_bf16 v[196:199], a[220:223], a[60:63], v[196:199]
    v_exp_f32 v93, -v129
    v_mfma_f32_16x16x32_bf16 v[196:199], a[192:195], a[28:31], v[196:199]
    v_exp_f32 v94, -v130
    v_mfma_f32_16x16x32_bf16 v[196:199], a[188:191], a[24:27], v[196:199]
    s_waitcnt lgkmcnt(0)
    v_exp_f32 v95, -v131
    v_mfma_f32_16x16x32_bf16 v[196:199], a[184:187], a[20:23], v[196:199]
    buffer_store_dwordx4 v[148:151], v47, s[28:31], 0 offen offset:1152 nt sc1
    ds_write_b64 v43, v[26:27] offset:2048
    v_mfma_f32_16x16x32_bf16 v[200:203], a[184:187], a[24:27], v[200:203]
    v_rcp_f32 v100, v100
    v_mfma_f32_16x16x32_bf16 v[200:203], a[188:191], a[28:31], v[200:203]
    v_rcp_f32 v101, v101
    v_mfma_f32_16x16x32_bf16 v[200:203], a[192:195], a[32:35], v[200:203]
    v_rcp_f32 v102, v102
    v_rcp_f32 v103, v103
    v_cvt_pk_bf16_f32 v104, v124, v125
    v_cvt_pk_bf16_f32 v105, v126, v127
    v_pk_fma_f32 v[160:161], v[160:161], v[60:61], v[64:65]
    v_pk_fma_f32 v[162:163], v[162:163], v[62:63], v[66:67]
    v_pk_fma_f32 v[92:93], v[92:93], s[50:51], s[50:51]
    v_pk_fma_f32 v[94:95], v[94:95], s[50:51], s[50:51]
    v_pk_mul_f32 v[156:157], v[156:157], v[100:101]
    v_pk_mul_f32 v[158:159], v[158:159], v[102:103]
    v_mfma_f32_16x16x32_bf16 v[200:203], a[220:223], a[64:67], v[200:203]
    ds_write_b64 v42, v[104:105] offset:3072
    ds_read_b128 v[152:155], v45 offset:2048
    v_mfma_f32_16x16x32_bf16 v[200:203], a[224:227], a[68:71], v[200:203]
    v_exp_f32 v96, -v160
    v_mfma_f32_16x16x32_bf16 v[200:203], a[228:231], a[72:75], v[200:203]
    v_exp_f32 v97, -v161
    v_mfma_f32_16x16x32_bf16 v[204:207], a[228:231], a[76:79], v[204:207]
    v_exp_f32 v98, -v162
    v_mfma_f32_16x16x32_bf16 v[204:207], a[224:227], a[72:75], v[204:207]
    v_exp_f32 v99, -v163
    v_mfma_f32_16x16x32_bf16 v[204:207], a[220:223], a[68:71], v[204:207]
    v_rcp_f32 v92, v92
    v_mfma_f32_16x16x32_bf16 v[204:207], a[192:195], a[36:39], v[204:207]
    v_rcp_f32 v93, v93
    v_mfma_f32_16x16x32_bf16 v[204:207], a[188:191], a[32:35], v[204:207]
    v_rcp_f32 v94, v94
    v_rcp_f32 v95, v95
    v_cvt_pk_bf16_f32 v106, v156, v157
    v_cvt_pk_bf16_f32 v107, v158, v159
    v_pk_fma_f32 v[132:133], v[132:133], v[52:53], v[56:57]
    v_pk_fma_f32 v[134:135], v[134:135], v[54:55], v[58:59]
    v_pk_fma_f32 v[96:97], v[96:97], s[50:51], s[50:51]
    v_pk_fma_f32 v[98:99], v[98:99], s[50:51], s[50:51]
    v_pk_mul_f32 v[128:129], v[128:129], v[92:93]
    v_pk_mul_f32 v[130:131], v[130:131], v[94:95]
    v_mfma_f32_16x16x32_bf16 v[204:207], a[184:187], a[28:31], v[204:207]
    s_waitcnt lgkmcnt(0)
    v_exp_f32 v100, -v132
    v_mfma_f32_16x16x32_bf16 v[176:179], a[160:163], a[80:83], v[176:179]
    buffer_store_dwordx4 v[152:155], v47, s[28:31], 0 offen offset:2304 nt sc1
    ds_write_b64 v43, v[106:107] offset:3072
    v_mfma_f32_16x16x32_bf16 v[176:179], a[164:167], a[84:87], v[176:179]
    v_exp_f32 v101, -v133
    v_mfma_f32_16x16x32_bf16 v[176:179], a[168:171], a[88:91], v[176:179]
    v_exp_f32 v102, -v134
    v_mfma_f32_16x16x32_bf16 v[176:179], a[172:175], a[120:123], v[176:179]
    v_exp_f32 v103, -v135
    v_mfma_f32_16x16x32_bf16 v[176:179], a[176:179], a[124:127], v[176:179]
    v_rcp_f32 v96, v96
    v_mfma_f32_16x16x32_bf16 v[176:179], a[180:183], a[128:131], v[176:179]
    ds_read_b128 v[156:159], v45 offset:3072
    v_mfma_f32_16x16x32_bf16 v[180:183], a[180:183], a[132:135], v[180:183]
    v_rcp_f32 v97, v97
    v_mfma_f32_16x16x32_bf16 v[180:183], a[176:179], a[128:131], v[180:183]
    v_rcp_f32 v98, v98
    v_rcp_f32 v99, v99
    v_cvt_pk_bf16_f32 v24, v128, v129
    v_cvt_pk_bf16_f32 v25, v130, v131
    v_pk_fma_f32 v[164:165], v[164:165], v[60:61], v[64:65]
    v_pk_fma_f32 v[166:167], v[166:167], v[62:63], v[66:67]
    v_pk_fma_f32 v[100:101], v[100:101], s[50:51], s[50:51]
    v_pk_fma_f32 v[102:103], v[102:103], s[50:51], s[50:51]
    v_pk_mul_f32 v[160:161], v[160:161], v[96:97]
    v_pk_mul_f32 v[162:163], v[162:163], v[98:99]
    v_mfma_f32_16x16x32_bf16 v[180:183], a[172:175], a[124:127], v[180:183]
    v_exp_f32 v92, -v164
    v_mfma_f32_16x16x32_bf16 v[180:183], a[168:171], a[92:95], v[180:183]
    v_exp_f32 v93, -v165
    v_mfma_f32_16x16x32_bf16 v[180:183], a[164:167], a[88:91], v[180:183]
    v_exp_f32 v94, -v166
    v_mfma_f32_16x16x32_bf16 v[180:183], a[160:163], a[84:87], v[180:183]
    v_exp_f32 v95, -v167
    v_mfma_f32_16x16x32_bf16 v[184:187], a[160:163], a[88:91], v[184:187]
    v_rcp_f32 v100, v100
    v_mfma_f32_16x16x32_bf16 v[184:187], a[164:167], a[92:95], v[184:187]
    s_waitcnt lgkmcnt(0)
    ds_write_b64 v42, v[24:25] offset:4096
    v_mfma_f32_16x16x32_bf16 v[184:187], a[168:171], a[96:99], v[184:187]
    v_rcp_f32 v101, v101
    v_mfma_f32_16x16x32_bf16 v[184:187], a[172:175], a[128:131], v[184:187]
    v_rcp_f32 v102, v102
    v_rcp_f32 v103, v103
    v_cvt_pk_bf16_f32 v26, v160, v161
    v_cvt_pk_bf16_f32 v27, v162, v163
    v_pk_fma_f32 v[136:137], v[136:137], v[52:53], v[56:57]
    v_pk_fma_f32 v[138:139], v[138:139], v[54:55], v[58:59]
    v_pk_fma_f32 v[92:93], v[92:93], s[50:51], s[50:51]
    v_pk_fma_f32 v[94:95], v[94:95], s[50:51], s[50:51]
    v_pk_mul_f32 v[132:133], v[132:133], v[100:101]
    v_pk_mul_f32 v[134:135], v[134:135], v[102:103]
    v_mfma_f32_16x16x32_bf16 v[184:187], a[176:179], a[132:135], v[184:187]
    ds_write_b64 v43, v[26:27] offset:4096
    buffer_store_dwordx4 v[156:159], v47, s[28:31], 0 offen offset:3456 nt sc1
    v_mfma_f32_16x16x32_bf16 v[184:187], a[180:183], a[136:139], v[184:187]
    v_exp_f32 v96, -v136
    v_mfma_f32_16x16x32_bf16 v[188:191], a[180:183], a[140:143], v[188:191]
    v_exp_f32 v97, -v137
    v_mfma_f32_16x16x32_bf16 v[188:191], a[176:179], a[136:139], v[188:191]
    v_exp_f32 v98, -v138
    v_mfma_f32_16x16x32_bf16 v[188:191], a[172:175], a[132:135], v[188:191]
    v_exp_f32 v99, -v139
    v_mfma_f32_16x16x32_bf16 v[188:191], a[168:171], a[100:103], v[188:191]
    ds_read_b128 v[160:163], v45 offset:4096
    v_mfma_f32_16x16x32_bf16 v[188:191], a[164:167], a[96:99], v[188:191]
    v_rcp_f32 v92, v92
    v_mfma_f32_16x16x32_bf16 v[188:191], a[160:163], a[92:95], v[188:191]
    v_rcp_f32 v93, v93
    v_mfma_f32_16x16x32_bf16 v[192:195], a[160:163], a[96:99], v[192:195]
    v_rcp_f32 v94, v94
    v_rcp_f32 v95, v95
    v_cvt_pk_bf16_f32 v104, v132, v133
    v_cvt_pk_bf16_f32 v105, v134, v135
    v_pk_fma_f32 v[168:169], v[168:169], v[60:61], v[64:65]
    v_pk_fma_f32 v[170:171], v[170:171], v[62:63], v[66:67]
    v_pk_fma_f32 v[96:97], v[96:97], s[50:51], s[50:51]
    v_pk_fma_f32 v[98:99], v[98:99], s[50:51], s[50:51]
    v_pk_mul_f32 v[164:165], v[164:165], v[92:93]
    v_pk_mul_f32 v[166:167], v[166:167], v[94:95]
    v_mfma_f32_16x16x32_bf16 v[192:195], a[164:167], a[100:103], v[192:195]
    v_exp_f32 v100, -v168
    v_mfma_f32_16x16x32_bf16 v[192:195], a[168:171], a[104:107], v[192:195]
    v_exp_f32 v101, -v169
    v_mfma_f32_16x16x32_bf16 v[192:195], a[172:175], a[136:139], v[192:195]
    v_exp_f32 v102, -v170
    v_mfma_f32_16x16x32_bf16 v[192:195], a[176:179], a[140:143], v[192:195]
    v_exp_f32 v103, -v171
    v_mfma_f32_16x16x32_bf16 v[192:195], a[180:183], a[144:147], v[192:195]
    s_waitcnt lgkmcnt(0)
    v_rcp_f32 v96, v96
    v_mfma_f32_16x16x32_bf16 v[196:199], a[180:183], a[148:151], v[196:199]
    buffer_store_dwordx4 v[160:163], v48, s[28:31], 0 offen offset:0 nt sc1
    ds_write_b64 v42, v[104:105] offset:5120
    v_mfma_f32_16x16x32_bf16 v[196:199], a[176:179], a[144:147], v[196:199]
    v_rcp_f32 v97, v97
    v_mfma_f32_16x16x32_bf16 v[196:199], a[172:175], a[140:143], v[196:199]
    s_lshl_b32 s46, s39, 2
    s_add_u32 s46, s46, s36
    s_cmp_lg_u32 s46, 0
    s_cbranch_scc1 L_nowb
    buffer_wbl2 sc1
L_nowb:
    v_mfma_f32_16x16x32_bf16 v[196:199], a[168:171], a[108:111], v[196:199]
    v_rcp_f32 v98, v98
    v_rcp_f32 v99, v99
    v_cvt_pk_bf16_f32 v106, v164, v165
    v_cvt_pk_bf16_f32 v107, v166, v167
    v_pk_fma_f32 v[140:141], v[140:141], v[52:53], v[56:57]
    v_pk_fma_f32 v[142:143], v[142:143], v[54:55], v[58:59]
    v_pk_fma_f32 v[100:101], v[100:101], s[50:51], s[50:51]
    v_pk_fma_f32 v[102:103], v[102:103], s[50:51], s[50:51]
    v_pk_mul_f32 v[136:137], v[136:137], v[96:97]
L_tp2:
    s_cbranch_vccnz L_back
    v_pk_mul_f32 v[138:139], v[138:139], v[98:99]
    v_mfma_f32_16x16x32_bf16 v[196:199], a[164:167], a[104:107], v[196:199]
    v_exp_f32 v92, -v140
    v_mfma_f32_16x16x32_bf16 v[196:199], a[160:163], a[100:103], v[196:199]
    v_exp_f32 v93, -v141
    v_mfma_f32_16x16x32_bf16 v[200:203], a[160:163], a[104:107], v[200:203]
    v_exp_f32 v94, -v142
    v_mfma_f32_16x16x32_bf16 v[200:203], a[164:167], a[108:111], v[200:203]
    v_exp_f32 v95, -v143
    v_mfma_f32_16x16x32_bf16 v[200:203], a[168:171], a[112:115], v[200:203]
    v_rcp_f32 v100, v100
    v_mfma_f32_16x16x32_bf16 v[200:203], a[172:175], a[144:147], v[200:203]
    ds_write_b64 v43, v[106:107] offset:5120
    ds_read_b128 v[164:167], v45 offset:5120
    v_mfma_f32_16x16x32_bf16 v[200:203], a[176:179], a[148:151], v[200:203]
    v_rcp_f32 v101, v101
    v_mfma_f32_16x16x32_bf16 v[200:203], a[180:183], a[152:155], v[200:203]
    v_rcp_f32 v102, v102
    v_rcp_f32 v103, v103
    v_cvt_pk_bf16_f32 v24, v136, v137
    v_cvt_pk_bf16_f32 v25, v138, v139
    v_pk_fma_f32 v[172:173], v[172:173], v[60:61], v[64:65]
    v_pk_fma_f32 v[174:175], v[174:175], v[62:63], v[66:67]
    v_pk_fma_f32 v[92:93], v[92:93], s[50:51], s[50:51]
    v_pk_fma_f32 v[94:95], v[94:95], s[50:51], s[50:51]
    v_pk_mul_f32 v[168:169], v[168:169], v[100:101]
    v_pk_mul_f32 v[170:171], v[170:171], v[102:103]
    v_mfma_f32_16x16x32_bf16 v[204:207], a[180:183], a[156:159], v[204:207]
    v_exp_f32 v96, -v172
    v_mfma_f32_16x16x32_bf16 v[204:207], a[176:179], a[152:155], v[204:207]
    v_exp_f32 v97, -v173
    v_mfma_f32_16x16x32_bf16 v[204:207], a[172:175], a[148:151], v[204:207]
    v_exp_f32 v98, -v174
    v_mfma_f32_16x16x32_bf16 v[204:207], a[168:171], a[116:119], v[204:207]
    v_exp_f32 v99, -v175
    v_mfma_f32_16x16x32_bf16 v[204:207], a[164:167], a[112:115], v[204:207]
    v_rcp_f32 v92, v92
    v_mfma_f32_16x16x32_bf16 v[204:207], a[160:163], a[108:111], v[204:207]
    s_waitcnt lgkmcnt(0)
    ds_write_b64 v42, v[24:25] offset:6144
    v_mfma_f32_16x16x32_bf16 v[208:211], a[196:199], a[0:3], v[208:211]
    v_rcp_f32 v93, v93
    v_mfma_f32_16x16x32_bf16 v[208:211], a[200:203], a[4:7], v[208:211]
    v_rcp_f32 v94, v94
    v_rcp_f32 v95, v95
    v_cvt_pk_bf16_f32 v26, v168, v169
    v_cvt_pk_bf16_f32 v27, v170, v171
    v_pk_fma_f32 v[176:177], v[176:177], v[68:69], v[72:73]
    v_pk_fma_f32 v[178:179], v[178:179], v[70:71], v[74:75]
    v_pk_fma_f32 v[96:97], v[96:97], s[50:51], s[50:51]
    v_pk_fma_f32 v[98:99], v[98:99], s[50:51], s[50:51]
    v_pk_mul_f32 v[140:141], v[140:141], v[92:93]
    v_pk_mul_f32 v[142:143], v[142:143], v[94:95]
    v_mfma_f32_16x16x32_bf16 v[208:211], a[204:207], a[8:11], v[208:211]
    ds_write_b64 v43, v[26:27] offset:6144
    buffer_store_dwordx4 v[164:167], v48, s[28:31], 0 offen offset:1152 nt sc1
    v_mfma_f32_16x16x32_bf16 v[208:211], a[208:211], a[40:43], v[208:211]
    v_exp_f32 v100, -v176
    v_mfma_f32_16x16x32_bf16 v[208:211], a[212:215], a[44:47], v[208:211]
    v_exp_f32 v101, -v177
    v_mfma_f32_16x16x32_bf16 v[208:211], a[216:219], a[48:51], v[208:211]
    v_exp_f32 v102, -v178
    v_mfma_f32_16x16x32_bf16 v[208:211], a[232:235], a[80:83], v[208:211]
    v_exp_f32 v103, -v179
    v_mfma_f32_16x16x32_bf16 v[208:211], a[236:239], a[84:87], v[208:211]
    ds_read_b128 v[168:171], v45 offset:6144
    v_mfma_f32_16x16x32_bf16 v[208:211], a[240:243], a[88:91], v[208:211]
    v_rcp_f32 v96, v96
    v_mfma_f32_16x16x32_bf16 v[208:211], a[244:247], a[120:123], v[208:211]
    v_rcp_f32 v97, v97
    v_mfma_f32_16x16x32_bf16 v[208:211], a[248:251], a[124:127], v[208:211]
    v_rcp_f32 v98, v98
    v_rcp_f32 v99, v99
    v_cvt_pk_bf16_f32 v104, v140, v141
    v_cvt_pk_bf16_f32 v105, v142, v143
    v_pk_fma_f32 v[180:181], v[180:181], v[68:69], v[72:73]
    v_pk_fma_f32 v[182:183], v[182:183], v[70:71], v[74:75]
    v_pk_fma_f32 v[100:101], v[100:101], s[50:51], s[50:51]
    v_pk_fma_f32 v[102:103], v[102:103], s[50:51], s[50:51]
    v_pk_mul_f32 v[172:173], v[172:173], v[96:97]
    v_pk_mul_f32 v[174:175], v[174:175], v[98:99]
    v_mfma_f32_16x16x32_bf16 v[208:211], a[252:255], a[128:131], v[208:211]
    v_exp_f32 v92, -v180
    v_mfma_f32_16x16x32_bf16 v[212:215], a[252:255], a[132:135], v[212:215]
    v_exp_f32 v93, -v181
    v_mfma_f32_16x16x32_bf16 v[212:215], a[248:251], a[128:131], v[212:215]
    v_exp_f32 v94, -v182
    v_mfma_f32_16x16x32_bf16 v[212:215], a[244:247], a[124:127], v[212:215]
    v_exp_f32 v95, -v183
    v_mfma_f32_16x16x32_bf16 v[212:215], a[240:243], a[92:95], v[212:215]
    s_waitcnt lgkmcnt(0)
    v_rcp_f32 v100, v100
    v_mfma_f32_16x16x32_bf16 v[212:215], a[236:239], a[88:91], v[212:215]
    buffer_store_dwordx4 v[168:171], v48, s[28:31], 0 offen offset:2304 nt sc1
    ds_write_b64 v42, v[104:105] offset:7168
    v_mfma_f32_16x16x32_bf16 v[212:215], a[232:235], a[84:87], v[212:215]
    v_rcp_f32 v101, v101
    v_mfma_f32_16x16x32_bf16 v[212:215], a[216:219], a[52:55], v[212:215]
    v_rcp_f32 v102, v102
    v_rcp_f32 v103, v103
    v_cvt_pk_bf16_f32 v106, v172, v173
    v_cvt_pk_bf16_f32 v107, v174, v175
    v_pk_fma_f32 v[208:209], v[208:209], v[76:77], v[80:81]
    v_pk_fma_f32 v[210:211], v[210:211], v[78:79], v[82:83]
    v_pk_fma_f32 v[92:93], v[92:93], s[50:51], s[50:51]
    v_pk_fma_f32 v[94:95], v[94:95], s[50:51], s[50:51]
    v_pk_mul_f32 v[176:177], v[176:177], v[100:101]
    v_pk_mul_f32 v[178:179], v[178:179], v[102:103]
    v_mfma_f32_16x16x32_bf16 v[212:215], a[212:215], a[48:51], v[212:215]
    v_exp_f32 v96, -v208
    v_mfma_f32_16x16x32_bf16 v[212:215], a[208:211], a[44:47], v[212:215]
    v_exp_f32 v97, -v209
    v_mfma_f32_16x16x32_bf16 v[212:215], a[204:207], a[12:15], v[212:215]
    v_exp_f32 v98, -v210
    v_mfma_f32_16x16x32_bf16 v[212:215], a[200:203], a[8:11], v[212:215]
    v_exp_f32 v99, -v211
    v_mfma_f32_16x16x32_bf16 v[212:215], a[196:199], a[4:7], v[212:215]
    v_rcp_f32 v92, v92
    v_mfma_f32_16x16x32_bf16 v[216:219], a[196:199], a[8:11], v[216:219]
    ds_write_b64 v43, v[106:107] offset:7168
    ds_read_b128 v[172:175], v45 offset:7168
    v_mfma_f32_16x16x32_bf16 v[216:219], a[200:203], a[12:15], v[216:219]
    v_rcp_f32 v93, v93
    v_mfma_f32_16x16x32_bf16 v[216:219], a[204:207], a[16:19], v[216:219]
    v_rcp_f32 v94, v94
    v_rcp_f32 v95, v95
    v_cvt_pk_bf16_f32 v24, v176, v177
    v_cvt_pk_bf16_f32 v25, v178, v179
    v_pk_fma_f32 v[184:185], v[184:185], v[68:69], v[72:73]
    v_pk_fma_f32 v[186:187], v[186:187], v[70:71], v[74:75]
    v_pk_fma_f32 v[96:97], v[96:97], s[50:51], s[50:51]
    v_pk_fma_f32 v[98:99], v[98:99], s[50:51], s[50:51]
    v_pk_mul_f32 v[180:181], v[180:181], v[92:93]
    v_pk_mul_f32 v[182:183], v[182:183], v[94:95]
    v_mfma_f32_16x16x32_bf16 v[216:219], a[208:211], a[48:51], v[216:219]
    v_exp_f32 v100, -v184
    v_mfma_f32_16x16x32_bf16 v[216:219], a[212:215], a[52:55], v[216:219]
    v_exp_f32 v101, -v185
    v_mfma_f32_16x16x32_bf16 v[216:219], a[216:219], a[56:59], v[216:219]
    v_exp_f32 v102, -v186
    v_mfma_f32_16x16x32_bf16 v[216:219], a[232:235], a[88:91], v[216:219]
    v_exp_f32 v103, -v187
    v_mfma_f32_16x16x32_bf16 v[216:219], a[236:239], a[92:95], v[216:219]
    v_rcp_f32 v96, v96
    v_mfma_f32_16x16x32_bf16 v[216:219], a[240:243], a[96:99], v[216:219]
    s_waitcnt lgkmcnt(0)
    ds_write_b64 v42, v[24:25] offset:0
    v_mfma_f32_16x16x32_bf16 v[216:219], a[244:247], a[128:131], v[216:219]
    v_rcp_f32 v97, v97
    v_mfma_f32_16x16x32_bf16 v[216:219], a[248:251], a[132:135], v[216:219]
    v_rcp_f32 v98, v98
    v_rcp_f32 v99, v99
    v_cvt_pk_bf16_f32 v26, v180, v181
    v_cvt_pk_bf16_f32 v27, v182, v183
    v_pk_fma_f32 v[212:213], v[212:213], v[76:77], v[80:81]
    v_pk_fma_f32 v[214:215], v[214:215], v[78:79], v[82:83]
    v_pk_fma_f32 v[100:101], v[100:101], s[50:51], s[50:51]
    v_pk_fma_f32 v[102:103], v[102:103], s[50:51], s[50:51]
    v_pk_mul_f32 v[208:209], v[208:209], v[96:97]
    v_pk_mul_f32 v[210:211], v[210:211], v[98:99]
    v_mfma_f32_16x16x32_bf16 v[216:219], a[252:255], a[136:139], v[216:219]
    ds_write_b64 v42, v[26:27] offset:1024
    buffer_store_dwordx4 v[172:175], v48, s[28:31], 0 offen offset:3456 nt sc1
    v_mfma_f32_16x16x32_bf16 v[220:223], a[252:255], a[140:143], v[220:223]
    v_exp_f32 v92, -v212
    v_mfma_f32_16x16x32_bf16 v[220:223], a[248:251], a[136:139], v[220:223]
    v_exp_f32 v93, -v213
    v_mfma_f32_16x16x32_bf16 v[220:223], a[244:247], a[132:135], v[220:223]
    v_exp_f32 v94, -v214
    v_mfma_f32_16x16x32_bf16 v[220:223], a[240:243], a[100:103], v[220:223]
    v_exp_f32 v95, -v215
    v_mfma_f32_16x16x32_bf16 v[220:223], a[236:239], a[96:99], v[220:223]
    v_rcp_f32 v100, v100
    v_mfma_f32_16x16x32_bf16 v[220:223], a[232:235], a[92:95], v[220:223]
    v_rcp_f32 v101, v101
    v_mfma_f32_16x16x32_bf16 v[220:223], a[216:219], a[60:63], v[220:223]
    v_rcp_f32 v102, v102
    v_rcp_f32 v103, v103
    v_cvt_pk_bf16_f32 v104, v208, v209
    v_cvt_pk_bf16_f32 v105, v210, v211
    v_pk_fma_f32 v[216:217], v[216:217], v[76:77], v[80:81]
    v_pk_fma_f32 v[218:219], v[218:219], v[78:79], v[82:83]
    v_pk_fma_f32 v[92:93], v[92:93], s[50:51], s[50:51]
    v_pk_fma_f32 v[94:95], v[94:95], s[50:51], s[50:51]
    v_pk_mul_f32 v[184:185], v[184:185], v[100:101]
    v_pk_mul_f32 v[186:187], v[186:187], v[102:103]
    v_mfma_f32_16x16x32_bf16 v[220:223], a[212:215], a[56:59], v[220:223]
    v_exp_f32 v96, -v216
    v_mfma_f32_16x16x32_bf16 v[220:223], a[208:211], a[52:55], v[220:223]
    v_exp_f32 v97, -v217
    v_mfma_f32_16x16x32_bf16 v[220:223], a[204:207], a[20:23], v[220:223]
    v_exp_f32 v98, -v218
    v_mfma_f32_16x16x32_bf16 v[220:223], a[200:203], a[16:19], v[220:223]
    v_exp_f32 v99, -v219
    v_mfma_f32_16x16x32_bf16 v[220:223], a[196:199], a[12:15], v[220:223]
    v_rcp_f32 v92, v92
    v_mfma_f32_16x16x32_bf16 v[224:227], a[196:199], a[16:19], v[224:227]
    ds_write_b64 v43, v[104:105] offset:0
    ds_read_b128 v[208:211], v45 offset:0
    v_mfma_f32_16x16x32_bf16 v[224:227], a[200:203], a[20:23], v[224:227]
    v_rcp_f32 v93, v93
    v_mfma_f32_16x16x32_bf16 v[224:227], a[204:207], a[24:27], v[224:227]
    v_rcp_f32 v94, v94
    v_rcp_f32 v95, v95
    v_cvt_pk_bf16_f32 v106, v184, v185
    v_cvt_pk_bf16_f32 v107, v186, v187
    v_pk_fma_f32 v[188:189], v[188:189], v[68:69], v[72:73]
    v_pk_fma_f32 v[190:191], v[190:191], v[70:71], v[74:75]
    v_pk_fma_f32 v[96:97], v[96:97], s[50:51], s[50:51]
    v_pk_fma_f32 v[98:99], v[98:99], s[50:51], s[50:51]
    v_pk_mul_f32 v[212:213], v[212:213], v[92:93]
    v_pk_mul_f32 v[214:215], v[214:215], v[94:95]
    v_mfma_f32_16x16x32_bf16 v[224:227], a[208:211], a[56:59], v[224:227]
    v_exp_f32 v100, -v188
    v_mfma_f32_16x16x32_bf16 v[224:227], a[212:215], a[60:63], v[224:227]
    v_exp_f32 v101, -v189
    v_mfma_f32_16x16x32_bf16 v[224:227], a[216:219], a[64:67], v[224:227]
    v_exp_f32 v102, -v190
    v_mfma_f32_16x16x32_bf16 v[224:227], a[232:235], a[96:99], v[224:227]
    v_exp_f32 v103, -v191
    v_mfma_f32_16x16x32_bf16 v[224:227], a[236:239], a[100:103], v[224:227]
    v_rcp_f32 v96, v96
    v_mfma_f32_16x16x32_bf16 v[224:227], a[240:243], a[104:107], v[224:227]
    s_waitcnt lgkmcnt(0)
    ds_write_b64 v42, v[106:107] offset:2048
    v_mfma_f32_16x16x32_bf16 v[224:227], a[244:247], a[136:139], v[224:227]
    v_rcp_f32 v97, v97
    v_mfma_f32_16x16x32_bf16 v[224:227], a[248:251], a[140:143], v[224:227]
    v_rcp_f32 v98, v98
    v_rcp_f32 v99, v99
    v_cvt_pk_bf16_f32 v24, v212, v213
    v_cvt_pk_bf16_f32 v25, v214, v215
    v_pk_fma_f32 v[220:221], v[220:221], v[76:77], v[80:81]
    v_pk_fma_f32 v[222:223], v[222:223], v[78:79], v[82:83]
    v_pk_fma_f32 v[100:101], v[100:101], s[50:51], s[50:51]
    v_pk_fma_f32 v[102:103], v[102:103], s[50:51], s[50:51]
    v_pk_mul_f32 v[216:217], v[216:217], v[96:97]
    v_pk_mul_f32 v[218:219], v[218:219], v[98:99]
    v_mfma_f32_16x16x32_bf16 v[224:227], a[252:255], a[144:147], v[224:227]
    ds_write_b64 v43, v[24:25] offset:1024
    buffer_store_dwordx4 v[208:211], v47, s[28:31], 0 offen offset:64 nt sc1
    v_mfma_f32_16x16x32_bf16 v[228:231], a[252:255], a[148:151], v[228:231]
    v_exp_f32 v92, -v220
    v_mfma_f32_16x16x32_bf16 v[228:231], a[248:251], a[144:147], v[228:231]
    v_exp_f32 v93, -v221
    v_mfma_f32_16x16x32_bf16 v[228:231], a[244:247], a[140:143], v[228:231]
    v_exp_f32 v94, -v222
    v_mfma_f32_16x16x32_bf16 v[228:231], a[240:243], a[108:111], v[228:231]
    v_exp_f32 v95, -v223
    v_mfma_f32_16x16x32_bf16 v[228:231], a[236:239], a[104:107], v[228:231]
    ds_read_b128 v[212:215], v45 offset:1024
    v_mfma_f32_16x16x32_bf16 v[228:231], a[232:235], a[100:103], v[228:231]
    v_rcp_f32 v100, v100
    v_mfma_f32_16x16x32_bf16 v[228:231], a[216:219], a[68:71], v[228:231]
    v_rcp_f32 v101, v101
    v_mfma_f32_16x16x32_bf16 v[228:231], a[212:215], a[64:67], v[228:231]
    v_rcp_f32 v102, v102
    v_rcp_f32 v103, v103
    v_cvt_pk_bf16_f32 v26, v216, v217
    v_cvt_pk_bf16_f32 v27, v218, v219
    v_pk_fma_f32 v[192:193], v[192:193], v[68:69], v[72:73]
    v_pk_fma_f32 v[194:195], v[194:195], v[70:71], v[74:75]
    v_pk_fma_f32 v[92:93], v[92:93], s[50:51], s[50:51]
    v_pk_fma_f32 v[94:95], v[94:95], s[50:51], s[50:51]
    v_pk_mul_f32 v[188:189], v[188:189], v[100:101]
    v_pk_mul_f32 v[190:191], v[190:191], v[102:103]
    v_mfma_f32_16x16x32_bf16 v[228:231], a[208:211], a[60:63], v[228:231]
    v_exp_f32 v96, -v192
    v_mfma_f32_16x16x32_bf16 v[228:231], a[204:207], a[28:31], v[228:231]
    v_exp_f32 v97, -v193
    v_mfma_f32_16x16x32_bf16 v[228:231], a[200:203], a[24:27], v[228:231]
    v_exp_f32 v98, -v194
    v_mfma_f32_16x16x32_bf16 v[228:231], a[196:199], a[20:23], v[228:231]
    v_exp_f32 v99, -v195
    v_mfma_f32_16x16x32_bf16 v[232:235], a[196:199], a[24:27], v[232:235]
    s_waitcnt lgkmcnt(0)
    v_rcp_f32 v92, v92
    v_mfma_f32_16x16x32_bf16 v[232:235], a[200:203], a[28:31], v[232:235]
    buffer_store_dwordx4 v[212:215], v47, s[28:31], 0 offen offset:1216 nt sc1
    ds_write_b64 v43, v[26:27] offset:2048
    v_mfma_f32_16x16x32_bf16 v[232:235], a[204:207], a[32:35], v[232:235]
    v_rcp_f32 v93, v93
    v_mfma_f32_16x16x32_bf16 v[232:235], a[208:211], a[64:67], v[232:235]
    v_rcp_f32 v94, v94
    v_rcp_f32 v95, v95
    v_cvt_pk_bf16_f32 v104, v188, v189
    v_cvt_pk_bf16_f32 v105, v190, v191
    v_pk_fma_f32 v[224:225], v[224:225], v[76:77], v[80:81]
    v_pk_fma_f32 v[226:227], v[226:227], v[78:79], v[82:83]
    v_pk_fma_f32 v[96:97], v[96:97], s[50:51], s[50:51]
    v_pk_fma_f32 v[98:99], v[98:99], s[50:51], s[50:51]
    v_pk_mul_f32 v[220:221], v[220:221], v[92:93]
    v_pk_mul_f32 v[222:223], v[222:223], v[94:95]
    v_mfma_f32_16x16x32_bf16 v[232:235], a[212:215], a[68:71], v[232:235]
    ds_write_b64 v42, v[104:105] offset:3072
    ds_read_b128 v[216:219], v45 offset:2048
    v_mfma_f32_16x16x32_bf16 v[232:235], a[216:219], a[72:75], v[232:235]
    v_exp_f32 v100, -v224
    v_mfma_f32_16x16x32_bf16 v[232:235], a[232:235], a[104:107], v[232:235]
    v_exp_f32 v101, -v225
    v_mfma_f32_16x16x32_bf16 v[232:235], a[236:239], a[108:111], v[232:235]
    v_exp_f32 v102, -v226
    v_mfma_f32_16x16x32_bf16 v[232:235], a[240:243], a[112:115], v[232:235]
    v_exp_f32 v103, -v227
    v_mfma_f32_16x16x32_bf16 v[232:235], a[244:247], a[144:147], v[232:235]
    v_rcp_f32 v96, v96
    v_mfma_f32_16x16x32_bf16 v[232:235], a[248:251], a[148:151], v[232:235]
    v_rcp_f32 v97, v97
    v_mfma_f32_16x16x32_bf16 v[232:235], a[252:255], a[152:155], v[232:235]
    v_rcp_f32 v98, v98
    v_rcp_f32 v99, v99
    v_cvt_pk_bf16_f32 v106, v220, v221
    v_cvt_pk_bf16_f32 v107, v222, v223
    v_pk_fma_f32 v[196:197], v[196:197], v[68:69], v[72:73]
    v_pk_fma_f32 v[198:199], v[198:199], v[70:71], v[74:75]
    v_pk_fma_f32 v[100:101], v[100:101], s[50:51], s[50:51]
    v_pk_fma_f32 v[102:103], v[102:103], s[50:51], s[50:51]
    v_pk_mul_f32 v[192:193], v[192:193], v[96:97]
    v_pk_mul_f32 v[194:195], v[194:195], v[98:99]
    v_mfma_f32_16x16x32_bf16 v[236:239], a[252:255], a[156:159], v[236:239]
    s_waitcnt lgkmcnt(0)
    v_exp_f32 v92, -v196
    v_mfma_f32_16x16x32_bf16 v[236:239], a[248:251], a[152:155], v[236:239]
    buffer_store_dwordx4 v[216:219], v47, s[28:31], 0 offen offset:2368 nt sc1
    ds_write_b64 v43, v[106:107] offset:3072
    v_mfma_f32_16x16x32_bf16 v[236:239], a[244:247], a[148:151], v[236:239]
    v_exp_f32 v93, -v197
    v_mfma_f32_16x16x32_bf16 v[236:239], a[240:243], a[116:119], v[236:239]
    v_exp_f32 v94, -v198
    v_mfma_f32_16x16x32_bf16 v[236:239], a[236:239], a[112:115], v[236:239]
    v_exp_f32 v95, -v199
    v_mfma_f32_16x16x32_bf16 v[236:239], a[232:235], a[108:111], v[236:239]
    v_rcp_f32 v100, v100
    v_mfma_f32_16x16x32_bf16 v[236:239], a[216:219], a[76:79], v[236:239]
    ds_read_b128 v[220:223], v45 offset:3072
    v_mfma_f32_16x16x32_bf16 v[236:239], a[212:215], a[72:75], v[236:239]
    v_rcp_f32 v101, v101
    v_mfma_f32_16x16x32_bf16 v[236:239], a[208:211], a[68:71], v[236:239]
    v_rcp_f32 v102, v102
    v_rcp_f32 v103, v103
    v_cvt_pk_bf16_f32 v24, v192, v193
    v_cvt_pk_bf16_f32 v25, v194, v195
    v_pk_fma_f32 v[228:229], v[228:229], v[76:77], v[80:81]
    v_pk_fma_f32 v[230:231], v[230:231], v[78:79], v[82:83]
    v_pk_fma_f32 v[92:93], v[92:93], s[50:51], s[50:51]
    v_pk_fma_f32 v[94:95], v[94:95], s[50:51], s[50:51]
    v_pk_mul_f32 v[224:225], v[224:225], v[100:101]
    v_pk_mul_f32 v[226:227], v[226:227], v[102:103]
    v_mfma_f32_16x16x32_bf16 v[236:239], a[204:207], a[36:39], v[236:239]
    v_exp_f32 v96, -v228
    v_mfma_f32_16x16x32_bf16 v[236:239], a[200:203], a[32:35], v[236:239]
    v_exp_f32 v97, -v229
    v_mfma_f32_16x16x32_bf16 v[236:239], a[196:199], a[28:31], v[236:239]
    v_exp_f32 v98, -v230
    v_exp_f32 v99, -v231
    ds_write_b64 v42, v[24:25] offset:4096
    v_rcp_f32 v92, v92
    s_waitcnt lgkmcnt(1)
    v_rcp_f32 v93, v93
    buffer_store_dwordx4 v[220:223], v47, s[28:31], 0 offen offset:3520 nt sc1
    v_rcp_f32 v94, v94
    v_rcp_f32 v95, v95
    v_cvt_pk_bf16_f32 v26, v224, v225
    v_cvt_pk_bf16_f32 v27, v226, v227
    v_pk_fma_f32 v[200:201], v[200:201], v[68:69], v[72:73]
    ds_write_b64 v43, v[26:27] offset:4096
    v_pk_fma_f32 v[202:203], v[202:203], v[70:71], v[74:75]
    ds_read_b128 v[224:227], v45 offset:4096
    v_pk_fma_f32 v[96:97], v[96:97], s[50:51], s[50:51]
    v_pk_fma_f32 v[98:99], v[98:99], s[50:51], s[50:51]
    v_pk_mul_f32 v[196:197], v[196:197], v[92:93]
    v_pk_mul_f32 v[198:199], v[198:199], v[94:95]
    v_exp_f32 v100, -v200
    v_exp_f32 v101, -v201
    v_exp_f32 v102, -v202
    v_exp_f32 v103, -v203
    s_waitcnt lgkmcnt(0)
    v_rcp_f32 v96, v96
    buffer_store_dwordx4 v[224:227], v48, s[28:31], 0 offen offset:64 nt sc1
    v_rcp_f32 v97, v97
    v_rcp_f32 v98, v98
    v_rcp_f32 v99, v99
    v_cvt_pk_bf16_f32 v104, v196, v197
    v_cvt_pk_bf16_f32 v105, v198, v199
    v_pk_fma_f32 v[232:233], v[232:233], v[76:77], v[80:81]
    ds_write_b64 v42, v[104:105] offset:5120
    v_pk_fma_f32 v[234:235], v[234:235], v[78:79], v[82:83]
    v_pk_fma_f32 v[100:101], v[100:101], s[50:51], s[50:51]
    v_pk_fma_f32 v[102:103], v[102:103], s[50:51], s[50:51]
    v_pk_mul_f32 v[228:229], v[228:229], v[96:97]
    v_pk_mul_f32 v[230:231], v[230:231], v[98:99]
    v_exp_f32 v92, -v232
    v_exp_f32 v93, -v233
    v_exp_f32 v94, -v234
    v_exp_f32 v95, -v235
    v_rcp_f32 v100, v100
    v_rcp_f32 v101, v101
    v_rcp_f32 v102, v102
    v_rcp_f32 v103, v103
    v_cvt_pk_bf16_f32 v106, v228, v229
    v_cvt_pk_bf16_f32 v107, v230, v231
    v_pk_fma_f32 v[204:205], v[204:205], v[68:69], v[72:73]
    ds_write_b64 v43, v[106:107] offset:5120
    v_pk_fma_f32 v[206:207], v[206:207], v[70:71], v[74:75]
    ds_read_b128 v[228:231], v45 offset:5120
    v_pk_fma_f32 v[92:93], v[92:93], s[50:51], s[50:51]
    v_pk_fma_f32 v[94:95], v[94:95], s[50:51], s[50:51]
    v_pk_mul_f32 v[200:201], v[200:201], v[100:101]
    v_pk_mul_f32 v[202:203], v[202:203], v[102:103]
    v_exp_f32 v96, -v204
    v_exp_f32 v97, -v205
    v_exp_f32 v98, -v206
    v_exp_f32 v99, -v207
    s_waitcnt lgkmcnt(0)
    v_rcp_f32 v92, v92
    buffer_store_dwordx4 v[228:231], v48, s[28:31], 0 offen offset:1216 nt sc1
    v_rcp_f32 v93, v93
    v_rcp_f32 v94, v94
    v_rcp_f32 v95, v95
    v_cvt_pk_bf16_f32 v24, v200, v201
    v_cvt_pk_bf16_f32 v25, v202, v203
    v_pk_fma_f32 v[236:237], v[236:237], v[76:77], v[80:81]
    ds_write_b64 v42, v[24:25] offset:6144
    v_pk_fma_f32 v[238:239], v[238:239], v[78:79], v[82:83]
    v_pk_fma_f32 v[96:97], v[96:97], s[50:51], s[50:51]
    v_pk_fma_f32 v[98:99], v[98:99], s[50:51], s[50:51]
    v_pk_mul_f32 v[232:233], v[232:233], v[92:93]
    v_pk_mul_f32 v[234:235], v[234:235], v[94:95]
    v_exp_f32 v100, -v236
    v_exp_f32 v101, -v237
    v_exp_f32 v102, -v238
    v_exp_f32 v103, -v239
    v_rcp_f32 v96, v96
    v_rcp_f32 v97, v97
    v_rcp_f32 v98, v98
    v_rcp_f32 v99, v99
    v_cvt_pk_bf16_f32 v26, v232, v233
    v_cvt_pk_bf16_f32 v27, v234, v235
    v_pk_fma_f32 v[100:101], v[100:101], s[50:51], s[50:51]
    ds_write_b64 v43, v[26:27] offset:6144
    v_pk_fma_f32 v[102:103], v[102:103], s[50:51], s[50:51]
    ds_read_b128 v[232:235], v45 offset:6144
    v_pk_mul_f32 v[204:205], v[204:205], v[96:97]
    v_pk_mul_f32 v[206:207], v[206:207], v[98:99]
    v_rcp_f32 v100, v100
    v_rcp_f32 v101, v101
    v_rcp_f32 v102, v102
    v_rcp_f32 v103, v103
    v_cvt_pk_bf16_f32 v104, v204, v205
    v_cvt_pk_bf16_f32 v105, v206, v207
    v_pk_mul_f32 v[236:237], v[236:237], v[100:101]
    ds_write_b64 v42, v[104:105] offset:7168
    v_pk_mul_f32 v[238:239], v[238:239], v[102:103]
    s_waitcnt lgkmcnt(1)
    v_cvt_pk_bf16_f32 v106, v236, v237
    buffer_store_dwordx4 v[232:235], v48, s[28:31], 0 offen offset:2368 nt sc1
    v_cvt_pk_bf16_f32 v107, v238, v239
    ds_write_b64 v43, v[106:107] offset:7168
    ds_read_b128 v[236:239], v45 offset:7168
    s_waitcnt lgkmcnt(0)
    buffer_store_dwordx4 v[236:239], v48, s[28:31], 0 offen offset:3520 nt sc1
    s_endpgm
L_code_end:
.section .rodata,"a"
.p2align 6
.amdhsa_kernel standalone__batchnorm__sampling_kernel
  .amdhsa_next_free_vgpr 512
  .amdhsa_next_free_sgpr 96
  .amdhsa_accum_offset 256
  .amdhsa_group_segment_fixed_size 0
  .amdhsa_kernarg_size 72
  .amdhsa_user_sgpr_count 2
  .amdhsa_user_sgpr_kernarg_segment_ptr 1
  .amdhsa_system_sgpr_workgroup_id_x 1
  .amdhsa_float_denorm_mode_32 3
.end_amdhsa_kernel
```
